```python
import torch

def _softmax(x, axis=-1):
    return torch.softmax(x, dim=axis)
def _gelu(x):
    return torch.nn.functional.gelu(x, approximate="tanh")
def _silu(x):
    return torch.nn.functional.silu(x)
def _sigmoid(x):
    return torch.sigmoid(x)
def _layernorm(x, axis=-1, eps=1e-5):
    m = x.mean(dim=axis, keepdim=True)
    v = x.var(dim=axis, keepdim=True, unbiased=False)
    return (x - m) / torch.sqrt(v + eps)
def _scatter_add(tgt, idx, src, axis=0):
    return tgt.clone().index_add_(axis, idx, src)
def _segment_sum(src, seg, n):
    out = torch.zeros((n,) + src.shape[1:], dtype=src.dtype)
    return out.index_add_(0, seg, src)
def _pad(x, pw):
    flat = tuple(v for pair in reversed(pw) for v in pair)
    return torch.nn.functional.pad(x, flat)

kernel_name = 'concat_heads__gqa_block_cached__mha_block_cached__near_ridge'

def setup_inputs():

    _w = (lambda a: (lambda t: t.to(torch.bfloat16) if t.is_floating_point() else t)(torch.as_tensor(a)))
    def _A_setup():
        B, Sq, D = 8, 128, 640
        Hq, Hkv, Sk, Dh = 32, 32, 512, 128
        assert Hq % Hkv == 0, (Hq, Hkv)
        return {
            "x": _w((lambda *s: torch.randn(*s, dtype=torch.bfloat16) * 0.8)(B, Sq, D)),
            "k_cache": _w((lambda *s: torch.randn(*s, dtype=torch.bfloat16) * 0.8)(B, Hkv, Sk, Dh)),
            "v_cache": _w((lambda *s: torch.randn(*s, dtype=torch.bfloat16) * 0.05)(B, Hkv, Sk, Dh)),
            "wq": _w((lambda *s: torch.randn(*s, dtype=torch.bfloat16) * 0.8)(D, Hq * Dh) * (D ** -0.5)),
            "wo": _w((lambda *s: torch.randn(*s, dtype=torch.bfloat16) * 0.05)(Hq * Dh, D) * ((Hq * Dh) ** -0.5)),
        }
    _A_in = _A_setup()

    def _B_setup():
        B, Sq, D = 8, 128, 640
        H, Sk, Dh = 32, 512, 128
        return {
            "x": _w((lambda *s: torch.randn(*s, dtype=torch.bfloat16) * 0.8)(B, Sq, D)),
            "k_cache": _w((lambda *s: torch.randn(*s, dtype=torch.bfloat16) * 0.8)(B, H, Sk, Dh)),
            "v_cache": _w((lambda *s: torch.randn(*s, dtype=torch.bfloat16) * 0.05)(B, H, Sk, Dh)),
            "wq": _w((lambda *s: torch.randn(*s, dtype=torch.bfloat16) * 0.8)(D, H * Dh) * (D ** -0.5)),
            "wo": _w((lambda *s: torch.randn(*s, dtype=torch.bfloat16) * 0.05)(H * Dh, D) * ((H * Dh) ** -0.5)),
        }
    _B_in = _B_setup()

    return {
        "A_x": _A_in["x"],
        "A_k_cache": _A_in["k_cache"],
        "A_v_cache": _A_in["v_cache"],
        "A_wq": _A_in["wq"],
        "A_wo": _A_in["wo"],
        "B_x": _B_in["x"],
        "B_k_cache": _B_in["k_cache"],
        "B_v_cache": _B_in["v_cache"],
        "B_wq": _B_in["wq"],
        "B_wo": _B_in["wo"],
    }

def reference(A_x, A_k_cache, A_v_cache, A_wq, A_wo, B_x, B_k_cache, B_v_cache, B_wq, B_wo):
    def _A_ref(x, k_cache, v_cache, wq, wo):
        B, Sq, D = x.shape
        Hq, Dh = 32, 128
        Hkv = k_cache.shape[1]
        rep = Hq // Hkv
        q = (lambda x, *d: x.permute(*d))((x @ wq).reshape(B, Sq, Hq, Dh), 0, 2, 1, 3)
        k = (lambda x, n, axis: torch.repeat_interleave(x, n, dim=axis))(k_cache, rep, axis=1)
        v = (lambda x, n, axis: torch.repeat_interleave(x, n, dim=axis))(v_cache, rep, axis=1)
        scores = torch.einsum("bhqd,bhkd->bhqk", q, k) * (Dh ** -0.5)
        p = _softmax(scores, axis=-1)
        o = torch.einsum("bhqk,bhkd->bhqd", p, v)
        return (lambda x, *d: x.permute(*d))(o, 0, 2, 1, 3).reshape(B, Sq, Hq * Dh) @ wo

    def _B_ref(x, k_cache, v_cache, wq, wo):
        B, Sq, D = x.shape
        H, Dh = 32, 128
        q = (lambda x, *d: x.permute(*d))((x @ wq).reshape(B, Sq, H, Dh), 0, 2, 1, 3)
        scores = torch.einsum("bhqd,bhkd->bhqk", q, k_cache) * (Dh ** -0.5)
        p = _softmax(scores, axis=-1)
        o = torch.einsum("bhqk,bhkd->bhqd", p, v_cache)
        return (lambda x, *d: x.permute(*d))(o, 0, 2, 1, 3).reshape(B, Sq, H * Dh) @ wo

    a = _A_ref(A_x, A_k_cache, A_v_cache, A_wq, A_wo)
    b = _B_ref(B_x, B_k_cache, B_v_cache, B_wq, B_wo)
    return torch.concatenate([a, b], axis=-1)
```

```asm
; @launch kernel=attn_kernel grid=(256,1,1) block=(512,1,1) lds=163840
; @launch kernel=reduce_kernel grid=(256,1,1) block=(640,1,1) lds=0
.amdgcn_target "amdgcn-amd-amdhsa--gfx950"
.text
    .globl attn_kernel
    .p2align 8
    .type attn_kernel,@function
attn_kernel:
    s_cmp_ge_u32 s2, 256
    s_cbranch_scc1 L_attn_end
    s_load_dwordx16 s[44:59], s[0:1], 0
    s_load_dwordx4 s[60:63], s[0:1], 64
    s_load_dwordx2 s[68:69], s[0:1], 96
    v_lshrrev_b32 v2, 6, v0
    v_and_b32 v1, 63, v0
    v_readfirstlane_b32 s3, v2
    s_nop 1
    s_lshr_b32 s4, s3, 2
    s_and_b32 s5, s3, 3
    s_and_b32 s9, s2, 7
    s_lshr_b32 s6, s9, 2
    s_and_b32 s9, s9, 3
    s_lshl_b32 s9, s9, 3
    s_lshr_b32 s10, s2, 3
    s_and_b32 s7, s10, 7
    s_add_u32 s7, s7, s9
    s_lshr_b32 s8, s10, 3
    s_lshl_b32 s8, s8, 1
    s_add_u32 s8, s8, s4
    s_mul_i32 s70, s4, 81920
    s_lshl_b32 s9, s5, 12
    s_add_u32 s77, s70, s9
    s_mov_b32 s76, 0x3e0293ee
    v_lshrrev_b32 v16, 4, v1
    v_and_b32 v17, 15, v1
    v_lshlrev_b32 v18, 2, v16
    v_xor_b32 v18, v18, v17
    v_lshlrev_b32 v18, 4, v18
    v_lshl_add_u32 v2, v16, 8, v18
    v_lshl_add_u32 v3, v16, 13, v18
    v_add_u32 v18, 0, v16
    v_xor_b32 v18, v18, v17
    v_lshlrev_b32 v18, 4, v18
    v_lshl_add_u32 v4, v16, 8, v18
    v_add_u32 v18, 4, v16
    v_xor_b32 v18, v18, v17
    v_lshlrev_b32 v18, 4, v18
    v_lshl_add_u32 v5, v16, 8, v18
    v_add_u32 v18, 8, v16
    v_xor_b32 v18, v18, v17
    v_lshlrev_b32 v18, 4, v18
    v_lshl_add_u32 v6, v16, 8, v18
    v_add_u32 v18, 12, v16
    v_xor_b32 v18, v18, v17
    v_lshlrev_b32 v18, 4, v18
    v_lshl_add_u32 v7, v16, 8, v18
    v_lshrrev_b32 v18, 2, v1
    v_mul_u32_u24 v18, 1280, v18
    v_and_b32 v19, 3, v1
    v_xor_b32 v19, v19, v16
    v_lshl_add_u32 v196, v19, 4, v18
    v_and_b32 v18, 31, v1
    v_bfe_u32 v19, v1, 2, 2
    v_lshrrev_b32 v20, 5, v1
    v_xor_b32 v19, v19, v20
    v_lshlrev_b32 v19, 4, v19
    v_lshl_add_u32 v18, v18, 6, v19
    s_lshl_b32 s9, s3, 11
    s_add_u32 s9, s9, 8192
    v_add_u32 v188, s9, v18
    v_xor_b32 v189, 32, v188
    v_add_u32 v190, 49152, v188
    v_add_u32 v191, 49152, v189
    v_add_u32 v192, 98304, v188
    v_add_u32 v193, 98304, v189
    v_lshrrev_b32 v16, 5, v1
    v_bfe_u32 v17, v1, 2, 2
    v_bfe_u32 v18, v1, 4, 1
    v_and_b32 v19, 1, v1
    v_bfe_u32 v20, v1, 1, 1
    v_lshl_add_u32 v21, v16, 3, v17
    v_lshlrev_b32 v21, 8, v21
    v_lshlrev_b32 v17, 2, v17
    v_lshl_add_u32 v17, v18, 1, v17
    v_add_u32 v17, v17, v19
    v_lshl_add_u32 v21, v17, 4, v21
    v_lshl_add_u32 v22, v20, 3, v21
    v_xor_b32 v176, 0, v22
    v_add_u32 v180, 49152, v176
    v_add_u32 v184, 98304, v176
    v_xor_b32 v177, 64, v22
    v_add_u32 v181, 49152, v177
    v_add_u32 v185, 98304, v177
    v_xor_b32 v178, 128, v22
    v_add_u32 v182, 49152, v178
    v_add_u32 v186, 98304, v178
    v_xor_b32 v179, 192, v22
    v_add_u32 v183, 49152, v179
    v_add_u32 v187, 98304, v179
    v_and_b32 v16, 19, v1
    v_bfe_u32 v17, v1, 2, 1
    v_lshl_add_u32 v16, v17, 3, v16
    v_bfe_u32 v17, v1, 3, 1
    v_lshl_add_u32 v16, v17, 2, v16
    v_lshrrev_b32 v17, 5, v1
    v_and_b32 v18, 15, v16
    v_xor_b32 v17, v17, v18
    v_lshlrev_b32 v17, 4, v17
    v_lshl_add_u32 v16, v16, 8, v17
    v_xor_b32 v17, 0, v16
    v_add_u32 v8, s70, v17
    v_xor_b32 v17, 32, v16
    v_add_u32 v9, s70, v17
    v_xor_b32 v17, 64, v16
    v_add_u32 v10, s70, v17
    v_xor_b32 v17, 96, v16
    v_add_u32 v11, s70, v17
    v_xor_b32 v17, 128, v16
    v_add_u32 v12, s70, v17
    v_xor_b32 v17, 160, v16
    v_add_u32 v13, s70, v17
    v_xor_b32 v17, 192, v16
    v_add_u32 v14, s70, v17
    v_xor_b32 v17, 224, v16
    v_add_u32 v15, s70, v17
    s_waitcnt lgkmcnt(0)
    s_cmp_eq_u32 s6, 0
    s_cselect_b64 s[44:45], s[44:45], s[54:55]
    s_cselect_b64 s[46:47], s[46:47], s[56:57]
    s_cselect_b64 s[48:49], s[48:49], s[58:59]
    s_cselect_b64 s[50:51], s[50:51], s[60:61]
    s_cselect_b64 s[52:53], s[52:53], s[62:63]
    s_mul_i32 s9, s8, 163840
    s_add_u32 s12, s44, s9
    s_addc_u32 s13, s45, 0
    s_mov_b32 s14, 163840
    s_mov_b32 s15, 0x00020000
    s_and_b32 s9, s8, 4
    s_mul_i32 s9, s9, 163840
    s_add_u32 s28, s44, s9
    s_addc_u32 s29, s45, 0
    s_mov_b32 s30, 655360
    s_mov_b32 s31, 0x00020000
    s_lshl_b32 s9, s7, 8
    s_add_u32 s16, s50, s9
    s_addc_u32 s17, s51, 0
    s_mov_b32 s18, 5234944
    s_mov_b32 s19, 0x00020000
    s_and_b32 s9, s9, 7680
    s_add_u32 s32, s50, s9
    s_addc_u32 s33, s51, 0
    s_mov_b32 s34, 5235200
    s_mov_b32 s35, 0x00020000
    s_lshl_b32 s9, s8, 5
    s_add_u32 s9, s9, s7
    s_lshl_b32 s9, s9, 17
    s_add_u32 s20, s46, s9
    s_addc_u32 s21, s47, 0
    s_mov_b32 s22, 131072
    s_mov_b32 s23, 0x00020000
    s_add_u32 s24, s48, s9
    s_addc_u32 s25, s49, 0
    s_mov_b32 s26, 131072
    s_mov_b32 s27, 0x00020000
    s_mov_b32 s36, s52
    s_mov_b32 s37, s53
    s_mov_b32 s38, 5242880
    s_mov_b32 s39, 0x00020000
    s_mov_b32 s40, s68
    s_mov_b32 s41, s69
    s_mov_b32 s42, 67108864
    s_mov_b32 s43, 0x00020000
    s_lshl_b32 s9, s5, 12
    s_add_u32 s73, s9, 49152
    s_add_u32 s74, s9, 32768
    s_lshl_b32 s71, s4, 14
    s_add_u32 s71, s71, 49152
    v_add_u32 v8, s71, v8
    v_add_u32 v9, s71, v9
    v_add_u32 v10, s71, v10
    v_add_u32 v11, s71, v11
    v_add_u32 v12, s71, v12
    v_add_u32 v13, s71, v13
    v_add_u32 v14, s71, v14
    v_add_u32 v15, s71, v15
    s_lshl_b32 s61, s3, 10
    s_lshl_b32 s60, s3, 11
    s_lshl_b32 s54, s3, 15
    s_mul_i32 s55, s5, 40960
    s_add_u32 s56, s55, 19456
    s_lshr_b32 s9, s2, 3
    s_and_b32 s64, s9, 7
    s_lshr_b32 s65, s9, 3
    s_and_b32 s9, s65, 2
    s_lshl_b32 s9, s9, 6
    v_add_u32 v16, s9, v1
    v_lshrrev_b32 v17, 1, v16
    v_and_b32 v16, 1, v16
    v_lshlrev_b32 v16, 7, v16
    v_lshl_add_u32 v20, v17, 13, v16
    s_lshl_b32 s9, s64, 5
    v_lshrrev_b32 v17, 1, v1
    v_add_u32 v17, s9, v17
    v_mul_u32_u24 v17, 1280, v17
    v_and_b32 v16, 1, v1
    v_lshl_add_u32 v21, v16, 7, v17
    s_lshr_b32 s78, s3, 1
    s_and_b32 s79, s78, 1
    s_cmp_lt_u32 s3, 4
    s_cselect_b32 s79, 0, s79
    s_cselect_b32 s78, s78, 2
    s_cbranch_scc1 L_pf_go0
    s_and_b32 s9, s65, 1
    s_cmp_eq_u32 s9, 0
    s_cbranch_scc1 L_pf_done
L_pf_go0:
    s_sub_u32 s10, s65, s79
    s_and_b32 s10, s10, 1
    s_and_b32 s9, s3, 1
    s_cmp_eq_u32 s9, 1
    s_cbranch_scc1 L_pf_x0
    s_lshl_b32 s10, s10, 18
    s_lshl_b32 s9, s78, 20
    s_add_u32 s9, s9, s10
    buffer_load_dword v18, v20, s[16:19], s9 offen
    s_branch L_pf_n0
L_pf_x0:
    s_mul_i32 s10, s10, 327680
    s_lshl_b32 s9, s78, 8
    s_add_u32 s9, s9, s10
    buffer_load_dword v18, v21, s[28:31], s9 offen
L_pf_n0:
    s_and_b32 s9, s65, 1
    s_cmp_eq_u32 s9, 0
    s_cbranch_scc1 L_pf_done
    s_lshr_b32 s78, s3, 2
    s_add_u32 s78, s78, 3
    s_lshr_b32 s79, s3, 1
    s_and_b32 s79, s79, 1
    s_sub_u32 s10, s65, s79
    s_and_b32 s10, s10, 1
    s_and_b32 s9, s3, 1
    s_cmp_eq_u32 s9, 1
    s_cbranch_scc1 L_pf_x1
    s_lshl_b32 s10, s10, 18
    s_lshl_b32 s9, s78, 20
    s_add_u32 s9, s9, s10
    buffer_load_dword v19, v20, s[16:19], s9 offen
    s_branch L_pf_n1
L_pf_x1:
    s_mul_i32 s10, s10, 327680
    s_lshl_b32 s9, s78, 8
    s_add_u32 s9, s9, s10
    buffer_load_dword v19, v21, s[28:31], s9 offen
L_pf_n1:
L_pf_done:
    s_barrier
    s_lshr_b32 s9, s2, 6
    s_and_b32 s9, s9, 1
    s_cmp_eq_u32 s9, 1
    s_cbranch_scc1 L_grpB
    s_lshl_b32 s79, s5, 12
    s_add_u32 s9, s61, 0
    s_mov_b32 m0, s9
    s_nop 0
    buffer_load_dwordx4 v3, s[16:19], s54 offen lds
    s_add_u32 s54, s54, 262144
    s_add_u32 s9, s60, 8192
    s_mov_b32 m0, s9
    s_nop 0
    buffer_load_dwordx4 v196, s[12:15], s55 offen lds
    s_add_u32 s55, s55, 64
    buffer_load_dwordx4 v196, s[12:15], s56 offen offset:1024 lds
    s_add_u32 s56, s56, 64
    s_add_u32 s9, s61, 24576
    s_mov_b32 m0, s9
    s_nop 0
    buffer_load_dwordx4 v3, s[16:19], s54 offen lds
    s_add_u32 s54, s54, 262144
    s_add_u32 s9, s60, 32768
    s_mov_b32 m0, s9
    s_nop 0
    buffer_load_dwordx4 v196, s[12:15], s55 offen lds
    s_add_u32 s55, s55, 64
    buffer_load_dwordx4 v196, s[12:15], s56 offen offset:1024 lds
    s_add_u32 s56, s56, 64
    s_add_u32 s9, s61, 49152
    s_mov_b32 m0, s9
    s_nop 0
    buffer_load_dwordx4 v3, s[16:19], s54 offen lds
    s_add_u32 s54, s54, 262144
    s_add_u32 s9, s60, 57344
    s_mov_b32 m0, s9
    s_nop 0
    buffer_load_dwordx4 v196, s[12:15], s55 offen lds
    s_add_u32 s55, s55, 64
    buffer_load_dwordx4 v196, s[12:15], s56 offen offset:1024 lds
    s_add_u32 s56, s56, 64
    s_waitcnt vmcnt(3)
    s_barrier
    ds_read_b128 v[200:203], v188
    ds_read_b64_tr_b16 v[16:17], v176
    ds_read_b64_tr_b16 v[18:19], v176 offset:1024
    ds_read_b64_tr_b16 v[20:21], v177
    ds_read_b64_tr_b16 v[22:23], v177 offset:1024
    ds_read_b64_tr_b16 v[24:25], v178
    ds_read_b64_tr_b16 v[26:27], v178 offset:1024
    ds_read_b64_tr_b16 v[28:29], v179
    ds_read_b64_tr_b16 v[30:31], v179 offset:1024
    ds_read_b128 v[204:207], v189
    ds_read_b64_tr_b16 v[216:217], v176 offset:4096
    ds_read_b64_tr_b16 v[218:219], v176 offset:5120
    ds_read_b64_tr_b16 v[220:221], v177 offset:4096
    ds_read_b64_tr_b16 v[222:223], v177 offset:5120
    s_waitcnt lgkmcnt(11)
    v_mfma_f32_32x32x16_bf16 v[32:47], v[16:19], v[200:203], 0
    s_add_u32 s9, s61, 73728
    s_mov_b32 m0, s9
    s_nop 0
    buffer_load_dwordx4 v3, s[16:19], s54 offen lds
    s_add_u32 s54, s54, 262144
    ds_read_b64_tr_b16 v[16:17], v178 offset:4096
    ds_read_b64_tr_b16 v[18:19], v178 offset:5120
    s_waitcnt lgkmcnt(11)
    v_mfma_f32_32x32x16_bf16 v[48:63], v[20:23], v[200:203], 0
    s_add_u32 s9, s60, 81920
    s_mov_b32 m0, s9
    s_nop 0
    buffer_load_dwordx4 v196, s[12:15], s55 offen lds
    s_add_u32 s55, s55, 64
    ds_read_b64_tr_b16 v[20:21], v179 offset:4096
    ds_read_b64_tr_b16 v[22:23], v179 offset:5120
    s_waitcnt lgkmcnt(11)
    v_mfma_f32_32x32x16_bf16 v[64:79], v[24:27], v[200:203], 0
    buffer_load_dwordx4 v196, s[12:15], s56 offen offset:1024 lds
    s_add_u32 s56, s56, 64
    ds_read_b128 v[208:211], v188 offset:24576
    ds_read_b64_tr_b16 v[24:25], v176 offset:24576
    ds_read_b64_tr_b16 v[26:27], v176 offset:25600
    s_waitcnt lgkmcnt(12)
    v_mfma_f32_32x32x16_bf16 v[80:95], v[28:31], v[200:203], 0
    s_add_u32 s9, s61, 98304
    s_mov_b32 m0, s9
    s_nop 0
    buffer_load_dwordx4 v3, s[16:19], s54 offen lds
    s_add_u32 s54, s54, 262144
    ds_read_b64_tr_b16 v[28:29], v177 offset:24576
    ds_read_b64_tr_b16 v[30:31], v177 offset:25600
    s_waitcnt lgkmcnt(11)
    v_mfma_f32_32x32x16_bf16 v[32:47], v[216:219], v[204:207], v[32:47]
    s_add_u32 s9, s60, 106496
    s_mov_b32 m0, s9
    s_nop 0
    buffer_load_dwordx4 v196, s[12:15], s55 offen lds
    s_add_u32 s55, s55, 64
    ds_read_b64_tr_b16 v[216:217], v178 offset:24576
    ds_read_b64_tr_b16 v[218:219], v178 offset:25600
    s_waitcnt lgkmcnt(11)
    v_mfma_f32_32x32x16_bf16 v[48:63], v[220:223], v[204:207], v[48:63]
    buffer_load_dwordx4 v196, s[12:15], s56 offen offset:1024 lds
    s_add_u32 s56, s56, 64
    ds_read_b64_tr_b16 v[220:221], v179 offset:24576
    ds_read_b64_tr_b16 v[222:223], v179 offset:25600
    s_waitcnt lgkmcnt(11)
    v_mfma_f32_32x32x16_bf16 v[64:79], v[16:19], v[204:207], v[64:79]
    ds_read_b128 v[212:215], v189 offset:24576
    ds_read_b64_tr_b16 v[16:17], v176 offset:28672
    ds_read_b64_tr_b16 v[18:19], v176 offset:29696
    s_waitcnt lgkmcnt(12)
    v_mfma_f32_32x32x16_bf16 v[80:95], v[20:23], v[204:207], v[80:95]
    s_waitcnt vmcnt(6)
    s_barrier
    ds_read_b64_tr_b16 v[20:21], v177 offset:28672
    ds_read_b64_tr_b16 v[22:23], v177 offset:29696
    s_waitcnt lgkmcnt(11)
    v_mfma_f32_32x32x16_bf16 v[32:47], v[24:27], v[208:211], v[32:47]
    s_add_u32 s9, s61, 122880
    s_mov_b32 m0, s9
    s_nop 0
    buffer_load_dwordx4 v3, s[16:19], s54 offen lds
    s_add_u32 s54, s54, 262144
    ds_read_b64_tr_b16 v[24:25], v178 offset:28672
    ds_read_b64_tr_b16 v[26:27], v178 offset:29696
    s_waitcnt lgkmcnt(11)
    v_mfma_f32_32x32x16_bf16 v[48:63], v[28:31], v[208:211], v[48:63]
    s_add_u32 s9, s60, 131072
    s_mov_b32 m0, s9
    s_nop 0
    buffer_load_dwordx4 v196, s[12:15], s55 offen lds
    s_add_u32 s55, s55, 64
    ds_read_b64_tr_b16 v[28:29], v179 offset:28672
    ds_read_b64_tr_b16 v[30:31], v179 offset:29696
    s_waitcnt lgkmcnt(11)
    v_mfma_f32_32x32x16_bf16 v[64:79], v[216:219], v[208:211], v[64:79]
    buffer_load_dwordx4 v196, s[12:15], s56 offen offset:1024 lds
    s_add_u32 s56, s56, 64
    ds_read_b128 v[200:203], v190
    ds_read_b64_tr_b16 v[216:217], v180
    ds_read_b64_tr_b16 v[218:219], v180 offset:1024
    s_waitcnt lgkmcnt(12)
    v_mfma_f32_32x32x16_bf16 v[80:95], v[220:223], v[208:211], v[80:95]
    s_add_u32 s9, s61, 0
    s_mov_b32 m0, s9
    s_nop 0
    buffer_load_dwordx4 v3, s[16:19], s54 offen lds
    s_add_u32 s54, s54, 262144
    ds_read_b64_tr_b16 v[220:221], v181
    ds_read_b64_tr_b16 v[222:223], v181 offset:1024
    s_waitcnt lgkmcnt(11)
    v_mfma_f32_32x32x16_bf16 v[32:47], v[16:19], v[212:215], v[32:47]
    s_add_u32 s9, s60, 8192
    s_mov_b32 m0, s9
    s_nop 0
    buffer_load_dwordx4 v196, s[12:15], s55 offen lds
    s_add_u32 s55, s55, 64
    ds_read_b64_tr_b16 v[16:17], v182
    ds_read_b64_tr_b16 v[18:19], v182 offset:1024
    s_waitcnt lgkmcnt(11)
    v_mfma_f32_32x32x16_bf16 v[48:63], v[20:23], v[212:215], v[48:63]
    buffer_load_dwordx4 v196, s[12:15], s56 offen offset:1024 lds
    s_add_u32 s56, s56, 64
    ds_read_b64_tr_b16 v[20:21], v183
    ds_read_b64_tr_b16 v[22:23], v183 offset:1024
    s_waitcnt lgkmcnt(11)
    v_mfma_f32_32x32x16_bf16 v[64:79], v[24:27], v[212:215], v[64:79]
    ds_read_b128 v[204:207], v191
    ds_read_b64_tr_b16 v[24:25], v180 offset:4096
    ds_read_b64_tr_b16 v[26:27], v180 offset:5120
    s_waitcnt lgkmcnt(12)
    v_mfma_f32_32x32x16_bf16 v[80:95], v[28:31], v[212:215], v[80:95]
    s_waitcnt vmcnt(9)
    s_barrier
    ds_read_b64_tr_b16 v[28:29], v181 offset:4096
    ds_read_b64_tr_b16 v[30:31], v181 offset:5120
    s_waitcnt lgkmcnt(11)
    v_mfma_f32_32x32x16_bf16 v[32:47], v[216:219], v[200:203], v[32:47]
    s_add_u32 s9, s61, 24576
    s_mov_b32 m0, s9
    s_nop 0
    buffer_load_dwordx4 v3, s[16:19], s54 offen lds
    s_add_u32 s54, s54, 262144
    ds_read_b64_tr_b16 v[216:217], v182 offset:4096
    ds_read_b64_tr_b16 v[218:219], v182 offset:5120
    s_waitcnt lgkmcnt(11)
    v_mfma_f32_32x32x16_bf16 v[48:63], v[220:223], v[200:203], v[48:63]
    s_add_u32 s9, s60, 32768
    s_mov_b32 m0, s9
    s_nop 0
    buffer_load_dwordx4 v196, s[12:15], s55 offen lds
    s_add_u32 s55, s55, 64
    ds_read_b64_tr_b16 v[220:221], v183 offset:4096
    ds_read_b64_tr_b16 v[222:223], v183 offset:5120
    s_waitcnt lgkmcnt(11)
    v_mfma_f32_32x32x16_bf16 v[64:79], v[16:19], v[200:203], v[64:79]
    buffer_load_dwordx4 v196, s[12:15], s56 offen offset:1024 lds
    s_add_u32 s56, s56, 64
    ds_read_b128 v[208:211], v190 offset:24576
    ds_read_b64_tr_b16 v[16:17], v180 offset:24576
    ds_read_b64_tr_b16 v[18:19], v180 offset:25600
    s_waitcnt lgkmcnt(12)
    v_mfma_f32_32x32x16_bf16 v[80:95], v[20:23], v[200:203], v[80:95]
    ds_read_b64_tr_b16 v[20:21], v181 offset:24576
    ds_read_b64_tr_b16 v[22:23], v181 offset:25600
    s_waitcnt lgkmcnt(11)
    v_mfma_f32_32x32x16_bf16 v[32:47], v[24:27], v[204:207], v[32:47]
    ds_read_b64_tr_b16 v[24:25], v182 offset:24576
    ds_read_b64_tr_b16 v[26:27], v182 offset:25600
    s_waitcnt lgkmcnt(11)
    v_mfma_f32_32x32x16_bf16 v[48:63], v[28:31], v[204:207], v[48:63]
    ds_read_b64_tr_b16 v[28:29], v183 offset:24576
    ds_read_b64_tr_b16 v[30:31], v183 offset:25600
    s_waitcnt lgkmcnt(11)
    v_mfma_f32_32x32x16_bf16 v[64:79], v[216:219], v[204:207], v[64:79]
    ds_read_b128 v[212:215], v191 offset:24576
    ds_read_b64_tr_b16 v[216:217], v180 offset:28672
    ds_read_b64_tr_b16 v[218:219], v180 offset:29696
    s_waitcnt lgkmcnt(12)
    v_mfma_f32_32x32x16_bf16 v[80:95], v[220:223], v[204:207], v[80:95]
    s_waitcnt vmcnt(9)
    s_barrier
    ds_read_b64_tr_b16 v[220:221], v181 offset:28672
    ds_read_b64_tr_b16 v[222:223], v181 offset:29696
    s_waitcnt lgkmcnt(11)
    v_mfma_f32_32x32x16_bf16 v[32:47], v[16:19], v[208:211], v[32:47]
    s_add_u32 s9, s61, 49152
    s_mov_b32 m0, s9
    s_nop 0
    buffer_load_dwordx4 v3, s[16:19], s54 offen lds
    s_add_u32 s54, s54, 262144
    ds_read_b64_tr_b16 v[16:17], v182 offset:28672
    ds_read_b64_tr_b16 v[18:19], v182 offset:29696
    s_waitcnt lgkmcnt(11)
    v_mfma_f32_32x32x16_bf16 v[48:63], v[20:23], v[208:211], v[48:63]
    s_add_u32 s9, s60, 57344
    s_mov_b32 m0, s9
    s_nop 0
    buffer_load_dwordx4 v196, s[12:15], s55 offen lds
    s_add_u32 s55, s55, 64
    ds_read_b64_tr_b16 v[20:21], v183 offset:28672
    ds_read_b64_tr_b16 v[22:23], v183 offset:29696
    s_waitcnt lgkmcnt(11)
    v_mfma_f32_32x32x16_bf16 v[64:79], v[24:27], v[208:211], v[64:79]
    buffer_load_dwordx4 v196, s[12:15], s56 offen offset:1024 lds
    s_add_u32 s56, s56, 64
    ds_read_b128 v[200:203], v192
    ds_read_b64_tr_b16 v[24:25], v184
    ds_read_b64_tr_b16 v[26:27], v184 offset:1024
    s_waitcnt lgkmcnt(12)
    v_mfma_f32_32x32x16_bf16 v[80:95], v[28:31], v[208:211], v[80:95]
    ds_read_b64_tr_b16 v[28:29], v185
    ds_read_b64_tr_b16 v[30:31], v185 offset:1024
    s_waitcnt lgkmcnt(11)
    v_mfma_f32_32x32x16_bf16 v[32:47], v[216:219], v[212:215], v[32:47]
    ds_read_b64_tr_b16 v[216:217], v186
    ds_read_b64_tr_b16 v[218:219], v186 offset:1024
    s_waitcnt lgkmcnt(11)
    v_mfma_f32_32x32x16_bf16 v[48:63], v[220:223], v[212:215], v[48:63]
    ds_read_b64_tr_b16 v[220:221], v187
    ds_read_b64_tr_b16 v[222:223], v187 offset:1024
    s_waitcnt lgkmcnt(11)
    v_mfma_f32_32x32x16_bf16 v[64:79], v[16:19], v[212:215], v[64:79]
    ds_read_b128 v[204:207], v193
    ds_read_b64_tr_b16 v[16:17], v184 offset:4096
    ds_read_b64_tr_b16 v[18:19], v184 offset:5120
    s_waitcnt lgkmcnt(12)
    v_mfma_f32_32x32x16_bf16 v[80:95], v[20:23], v[212:215], v[80:95]
    s_waitcnt vmcnt(9)
    s_barrier
    ds_read_b64_tr_b16 v[20:21], v185 offset:4096
    ds_read_b64_tr_b16 v[22:23], v185 offset:5120
    s_waitcnt lgkmcnt(11)
    v_mfma_f32_32x32x16_bf16 v[32:47], v[24:27], v[200:203], v[32:47]
    s_add_u32 s9, s61, 73728
    s_mov_b32 m0, s9
    s_nop 0
    buffer_load_dwordx4 v3, s[16:19], s54 offen lds
    s_add_u32 s54, s54, 262144
    ds_read_b64_tr_b16 v[24:25], v186 offset:4096
    ds_read_b64_tr_b16 v[26:27], v186 offset:5120
    s_waitcnt lgkmcnt(11)
    v_mfma_f32_32x32x16_bf16 v[48:63], v[28:31], v[200:203], v[48:63]
    s_add_u32 s9, s60, 81920
    s_mov_b32 m0, s9
    s_nop 0
    buffer_load_dwordx4 v196, s[12:15], s55 offen lds
    s_add_u32 s55, s55, 64
    ds_read_b64_tr_b16 v[28:29], v187 offset:4096
    ds_read_b64_tr_b16 v[30:31], v187 offset:5120
    s_waitcnt lgkmcnt(11)
    v_mfma_f32_32x32x16_bf16 v[64:79], v[216:219], v[200:203], v[64:79]
    buffer_load_dwordx4 v196, s[12:15], s56 offen offset:1024 lds
    s_add_u32 s56, s56, 64
    ds_read_b128 v[208:211], v192 offset:24576
    ds_read_b64_tr_b16 v[216:217], v184 offset:24576
    ds_read_b64_tr_b16 v[218:219], v184 offset:25600
    s_waitcnt lgkmcnt(12)
    v_mfma_f32_32x32x16_bf16 v[80:95], v[220:223], v[200:203], v[80:95]
    ds_read_b64_tr_b16 v[220:221], v185 offset:24576
    ds_read_b64_tr_b16 v[222:223], v185 offset:25600
    s_waitcnt lgkmcnt(11)
    v_mfma_f32_32x32x16_bf16 v[32:47], v[16:19], v[204:207], v[32:47]
    ds_read_b64_tr_b16 v[16:17], v186 offset:24576
    ds_read_b64_tr_b16 v[18:19], v186 offset:25600
    s_waitcnt lgkmcnt(11)
    v_mfma_f32_32x32x16_bf16 v[48:63], v[20:23], v[204:207], v[48:63]
    ds_read_b64_tr_b16 v[20:21], v187 offset:24576
    ds_read_b64_tr_b16 v[22:23], v187 offset:25600
    s_waitcnt lgkmcnt(11)
    v_mfma_f32_32x32x16_bf16 v[64:79], v[24:27], v[204:207], v[64:79]
    ds_read_b128 v[212:215], v193 offset:24576
    ds_read_b64_tr_b16 v[24:25], v184 offset:28672
    ds_read_b64_tr_b16 v[26:27], v184 offset:29696
    s_waitcnt lgkmcnt(12)
    v_mfma_f32_32x32x16_bf16 v[80:95], v[28:31], v[204:207], v[80:95]
    s_waitcnt vmcnt(9)
    s_barrier
    ds_read_b64_tr_b16 v[28:29], v185 offset:28672
    ds_read_b64_tr_b16 v[30:31], v185 offset:29696
    s_waitcnt lgkmcnt(11)
    v_mfma_f32_32x32x16_bf16 v[32:47], v[216:219], v[208:211], v[32:47]
    s_add_u32 s9, s61, 98304
    s_mov_b32 m0, s9
    s_nop 0
    buffer_load_dwordx4 v3, s[16:19], s54 offen lds
    s_add_u32 s54, s54, 262144
    ds_read_b64_tr_b16 v[216:217], v186 offset:28672
    ds_read_b64_tr_b16 v[218:219], v186 offset:29696
    s_waitcnt lgkmcnt(11)
    v_mfma_f32_32x32x16_bf16 v[48:63], v[220:223], v[208:211], v[48:63]
    s_add_u32 s9, s60, 106496
    s_mov_b32 m0, s9
    s_nop 0
    buffer_load_dwordx4 v196, s[12:15], s55 offen lds
    s_add_u32 s55, s55, 64
    ds_read_b64_tr_b16 v[220:221], v187 offset:28672
    ds_read_b64_tr_b16 v[222:223], v187 offset:29696
    s_waitcnt lgkmcnt(11)
    v_mfma_f32_32x32x16_bf16 v[64:79], v[16:19], v[208:211], v[64:79]
    buffer_load_dwordx4 v196, s[12:15], s56 offen offset:1024 lds
    s_add_u32 s56, s56, 64
    ds_read_b128 v[200:203], v188
    ds_read_b64_tr_b16 v[16:17], v176
    ds_read_b64_tr_b16 v[18:19], v176 offset:1024
    s_waitcnt lgkmcnt(12)
    v_mfma_f32_32x32x16_bf16 v[80:95], v[20:23], v[208:211], v[80:95]
    ds_read_b64_tr_b16 v[20:21], v177
    ds_read_b64_tr_b16 v[22:23], v177 offset:1024
    s_waitcnt lgkmcnt(11)
    v_mfma_f32_32x32x16_bf16 v[32:47], v[24:27], v[212:215], v[32:47]
    ds_read_b64_tr_b16 v[24:25], v178
    ds_read_b64_tr_b16 v[26:27], v178 offset:1024
    s_waitcnt lgkmcnt(11)
    v_mfma_f32_32x32x16_bf16 v[48:63], v[28:31], v[212:215], v[48:63]
    ds_read_b64_tr_b16 v[28:29], v179
    ds_read_b64_tr_b16 v[30:31], v179 offset:1024
    s_waitcnt lgkmcnt(11)
    v_mfma_f32_32x32x16_bf16 v[64:79], v[216:219], v[212:215], v[64:79]
    ds_read_b128 v[204:207], v189
    ds_read_b64_tr_b16 v[216:217], v176 offset:4096
    ds_read_b64_tr_b16 v[218:219], v176 offset:5120
    s_waitcnt lgkmcnt(12)
    v_mfma_f32_32x32x16_bf16 v[80:95], v[220:223], v[212:215], v[80:95]
    s_waitcnt vmcnt(9)
    s_barrier
    ds_read_b64_tr_b16 v[220:221], v177 offset:4096
    ds_read_b64_tr_b16 v[222:223], v177 offset:5120
    s_waitcnt lgkmcnt(11)
    v_mfma_f32_32x32x16_bf16 v[32:47], v[16:19], v[200:203], v[32:47]
    s_add_u32 s9, s61, 122880
    s_mov_b32 m0, s9
    s_nop 0
    buffer_load_dwordx4 v3, s[16:19], s54 offen lds
    s_add_u32 s54, s54, 262144
    ds_read_b64_tr_b16 v[16:17], v178 offset:4096
    ds_read_b64_tr_b16 v[18:19], v178 offset:5120
    s_waitcnt lgkmcnt(11)
    v_mfma_f32_32x32x16_bf16 v[48:63], v[20:23], v[200:203], v[48:63]
    s_add_u32 s9, s60, 131072
    s_mov_b32 m0, s9
    s_nop 0
    buffer_load_dwordx4 v196, s[12:15], s55 offen lds
    s_add_u32 s55, s55, 64
    ds_read_b64_tr_b16 v[20:21], v179 offset:4096
    ds_read_b64_tr_b16 v[22:23], v179 offset:5120
    s_waitcnt lgkmcnt(11)
    v_mfma_f32_32x32x16_bf16 v[64:79], v[24:27], v[200:203], v[64:79]
    buffer_load_dwordx4 v196, s[12:15], s56 offen offset:1024 lds
    s_add_u32 s56, s56, 64
    ds_read_b128 v[208:211], v188 offset:24576
    ds_read_b64_tr_b16 v[24:25], v176 offset:24576
    ds_read_b64_tr_b16 v[26:27], v176 offset:25600
    s_waitcnt lgkmcnt(12)
    v_mfma_f32_32x32x16_bf16 v[80:95], v[28:31], v[200:203], v[80:95]
    ds_read_b64_tr_b16 v[28:29], v177 offset:24576
    ds_read_b64_tr_b16 v[30:31], v177 offset:25600
    s_waitcnt lgkmcnt(11)
    v_mfma_f32_32x32x16_bf16 v[32:47], v[216:219], v[204:207], v[32:47]
    ds_read_b64_tr_b16 v[216:217], v178 offset:24576
    ds_read_b64_tr_b16 v[218:219], v178 offset:25600
    s_waitcnt lgkmcnt(11)
    v_mfma_f32_32x32x16_bf16 v[48:63], v[220:223], v[204:207], v[48:63]
    ds_read_b64_tr_b16 v[220:221], v179 offset:24576
    ds_read_b64_tr_b16 v[222:223], v179 offset:25600
    s_waitcnt lgkmcnt(11)
    v_mfma_f32_32x32x16_bf16 v[64:79], v[16:19], v[204:207], v[64:79]
    ds_read_b128 v[212:215], v189 offset:24576
    ds_read_b64_tr_b16 v[16:17], v176 offset:28672
    ds_read_b64_tr_b16 v[18:19], v176 offset:29696
    s_waitcnt lgkmcnt(12)
    v_mfma_f32_32x32x16_bf16 v[80:95], v[20:23], v[204:207], v[80:95]
    s_waitcnt vmcnt(9)
    s_barrier
    ds_read_b64_tr_b16 v[20:21], v177 offset:28672
    ds_read_b64_tr_b16 v[22:23], v177 offset:29696
    s_waitcnt lgkmcnt(11)
    v_mfma_f32_32x32x16_bf16 v[32:47], v[24:27], v[208:211], v[32:47]
    s_add_u32 s9, s61, 0
    s_mov_b32 m0, s9
    s_nop 0
    buffer_load_dwordx4 v3, s[16:19], s54 offen lds
    s_add_u32 s54, s54, 262144
    ds_read_b64_tr_b16 v[24:25], v178 offset:28672
    ds_read_b64_tr_b16 v[26:27], v178 offset:29696
    s_waitcnt lgkmcnt(11)
    v_mfma_f32_32x32x16_bf16 v[48:63], v[28:31], v[208:211], v[48:63]
    s_add_u32 s9, s60, 8192
    s_mov_b32 m0, s9
    s_nop 0
    buffer_load_dwordx4 v196, s[12:15], s55 offen lds
    s_add_u32 s55, s55, 64
    ds_read_b64_tr_b16 v[28:29], v179 offset:28672
    ds_read_b64_tr_b16 v[30:31], v179 offset:29696
    s_waitcnt lgkmcnt(11)
    v_mfma_f32_32x32x16_bf16 v[64:79], v[216:219], v[208:211], v[64:79]
    buffer_load_dwordx4 v196, s[12:15], s56 offen offset:1024 lds
    s_add_u32 s56, s56, 64
    ds_read_b128 v[200:203], v190
    ds_read_b64_tr_b16 v[216:217], v180
    ds_read_b64_tr_b16 v[218:219], v180 offset:1024
    s_waitcnt lgkmcnt(12)
    v_mfma_f32_32x32x16_bf16 v[80:95], v[220:223], v[208:211], v[80:95]
    ds_read_b64_tr_b16 v[220:221], v181
    ds_read_b64_tr_b16 v[222:223], v181 offset:1024
    s_waitcnt lgkmcnt(11)
    v_mfma_f32_32x32x16_bf16 v[32:47], v[16:19], v[212:215], v[32:47]
    ds_read_b64_tr_b16 v[16:17], v182
    ds_read_b64_tr_b16 v[18:19], v182 offset:1024
    s_waitcnt lgkmcnt(11)
    v_mfma_f32_32x32x16_bf16 v[48:63], v[20:23], v[212:215], v[48:63]
    ds_read_b64_tr_b16 v[20:21], v183
    ds_read_b64_tr_b16 v[22:23], v183 offset:1024
    s_waitcnt lgkmcnt(11)
    v_mfma_f32_32x32x16_bf16 v[64:79], v[24:27], v[212:215], v[64:79]
    ds_read_b128 v[204:207], v191
    ds_read_b64_tr_b16 v[24:25], v180 offset:4096
    ds_read_b64_tr_b16 v[26:27], v180 offset:5120
    s_waitcnt lgkmcnt(12)
    v_mfma_f32_32x32x16_bf16 v[80:95], v[28:31], v[212:215], v[80:95]
    s_waitcnt vmcnt(9)
    s_barrier
    ds_read_b64_tr_b16 v[28:29], v181 offset:4096
    ds_read_b64_tr_b16 v[30:31], v181 offset:5120
    s_waitcnt lgkmcnt(11)
    v_mfma_f32_32x32x16_bf16 v[32:47], v[216:219], v[200:203], v[32:47]
    s_add_u32 s9, s61, 24576
    s_mov_b32 m0, s9
    s_nop 0
    buffer_load_dwordx4 v3, s[16:19], s54 offen lds
    s_add_u32 s54, s54, 262144
    ds_read_b64_tr_b16 v[216:217], v182 offset:4096
    ds_read_b64_tr_b16 v[218:219], v182 offset:5120
    s_waitcnt lgkmcnt(11)
    v_mfma_f32_32x32x16_bf16 v[48:63], v[220:223], v[200:203], v[48:63]
    s_add_u32 s9, s60, 32768
    s_mov_b32 m0, s9
    s_nop 0
    buffer_load_dwordx4 v196, s[12:15], s55 offen lds
    s_add_u32 s55, s55, 64
    ds_read_b64_tr_b16 v[220:221], v183 offset:4096
    ds_read_b64_tr_b16 v[222:223], v183 offset:5120
    s_waitcnt lgkmcnt(11)
    v_mfma_f32_32x32x16_bf16 v[64:79], v[16:19], v[200:203], v[64:79]
    buffer_load_dwordx4 v196, s[12:15], s56 offen offset:1024 lds
    s_add_u32 s56, s56, 64
    ds_read_b128 v[208:211], v190 offset:24576
    ds_read_b64_tr_b16 v[16:17], v180 offset:24576
    ds_read_b64_tr_b16 v[18:19], v180 offset:25600
    s_waitcnt lgkmcnt(12)
    v_mfma_f32_32x32x16_bf16 v[80:95], v[20:23], v[200:203], v[80:95]
    ds_read_b64_tr_b16 v[20:21], v181 offset:24576
    ds_read_b64_tr_b16 v[22:23], v181 offset:25600
    s_waitcnt lgkmcnt(11)
    v_mfma_f32_32x32x16_bf16 v[32:47], v[24:27], v[204:207], v[32:47]
    ds_read_b64_tr_b16 v[24:25], v182 offset:24576
    ds_read_b64_tr_b16 v[26:27], v182 offset:25600
    s_waitcnt lgkmcnt(11)
    v_mfma_f32_32x32x16_bf16 v[48:63], v[28:31], v[204:207], v[48:63]
    ds_read_b64_tr_b16 v[28:29], v183 offset:24576
    ds_read_b64_tr_b16 v[30:31], v183 offset:25600
    s_waitcnt lgkmcnt(11)
    v_mfma_f32_32x32x16_bf16 v[64:79], v[216:219], v[204:207], v[64:79]
    ds_read_b128 v[212:215], v191 offset:24576
    ds_read_b64_tr_b16 v[216:217], v180 offset:28672
    ds_read_b64_tr_b16 v[218:219], v180 offset:29696
    s_waitcnt lgkmcnt(12)
    v_mfma_f32_32x32x16_bf16 v[80:95], v[220:223], v[204:207], v[80:95]
    s_waitcnt vmcnt(9)
    s_barrier
    ds_read_b64_tr_b16 v[220:221], v181 offset:28672
    ds_read_b64_tr_b16 v[222:223], v181 offset:29696
    s_waitcnt lgkmcnt(11)
    v_mfma_f32_32x32x16_bf16 v[32:47], v[16:19], v[208:211], v[32:47]
    s_add_u32 s9, s61, 49152
    s_mov_b32 m0, s9
    s_nop 0
    buffer_load_dwordx4 v3, s[16:19], s54 offen lds
    s_add_u32 s54, s54, 262144
    ds_read_b64_tr_b16 v[16:17], v182 offset:28672
    ds_read_b64_tr_b16 v[18:19], v182 offset:29696
    s_waitcnt lgkmcnt(11)
    v_mfma_f32_32x32x16_bf16 v[48:63], v[20:23], v[208:211], v[48:63]
    s_add_u32 s9, s60, 57344
    s_mov_b32 m0, s9
    s_nop 0
    buffer_load_dwordx4 v196, s[12:15], s55 offen lds
    s_add_u32 s55, s55, 64
    ds_read_b64_tr_b16 v[20:21], v183 offset:28672
    ds_read_b64_tr_b16 v[22:23], v183 offset:29696
    s_waitcnt lgkmcnt(11)
    v_mfma_f32_32x32x16_bf16 v[64:79], v[24:27], v[208:211], v[64:79]
    buffer_load_dwordx4 v196, s[12:15], s56 offen offset:1024 lds
    s_add_u32 s56, s56, 64
    ds_read_b128 v[200:203], v192
    ds_read_b64_tr_b16 v[24:25], v184
    ds_read_b64_tr_b16 v[26:27], v184 offset:1024
    s_waitcnt lgkmcnt(12)
    v_mfma_f32_32x32x16_bf16 v[80:95], v[28:31], v[208:211], v[80:95]
    ds_read_b64_tr_b16 v[28:29], v185
    ds_read_b64_tr_b16 v[30:31], v185 offset:1024
    s_waitcnt lgkmcnt(11)
    v_mfma_f32_32x32x16_bf16 v[32:47], v[216:219], v[212:215], v[32:47]
    ds_read_b64_tr_b16 v[216:217], v186
    ds_read_b64_tr_b16 v[218:219], v186 offset:1024
    s_waitcnt lgkmcnt(11)
    v_mfma_f32_32x32x16_bf16 v[48:63], v[220:223], v[212:215], v[48:63]
    ds_read_b64_tr_b16 v[220:221], v187
    ds_read_b64_tr_b16 v[222:223], v187 offset:1024
    s_waitcnt lgkmcnt(11)
    v_mfma_f32_32x32x16_bf16 v[64:79], v[16:19], v[212:215], v[64:79]
    ds_read_b128 v[204:207], v193
    ds_read_b64_tr_b16 v[16:17], v184 offset:4096
    ds_read_b64_tr_b16 v[18:19], v184 offset:5120
    s_waitcnt lgkmcnt(12)
    v_mfma_f32_32x32x16_bf16 v[80:95], v[20:23], v[212:215], v[80:95]
    s_waitcnt vmcnt(9)
    s_barrier
    ds_read_b64_tr_b16 v[20:21], v185 offset:4096
    ds_read_b64_tr_b16 v[22:23], v185 offset:5120
    s_waitcnt lgkmcnt(11)
    v_mfma_f32_32x32x16_bf16 v[32:47], v[24:27], v[200:203], v[32:47]
    s_add_u32 s9, s61, 73728
    s_mov_b32 m0, s9
    s_nop 0
    buffer_load_dwordx4 v3, s[16:19], s54 offen lds
    s_add_u32 s54, s54, 262144
    ds_read_b64_tr_b16 v[24:25], v186 offset:4096
    ds_read_b64_tr_b16 v[26:27], v186 offset:5120
    s_waitcnt lgkmcnt(11)
    v_mfma_f32_32x32x16_bf16 v[48:63], v[28:31], v[200:203], v[48:63]
    s_add_u32 s9, s60, 81920
    s_mov_b32 m0, s9
    s_nop 0
    buffer_load_dwordx4 v196, s[12:15], s55 offen lds
    s_add_u32 s55, s55, 64
    ds_read_b64_tr_b16 v[28:29], v187 offset:4096
    ds_read_b64_tr_b16 v[30:31], v187 offset:5120
    s_waitcnt lgkmcnt(11)
    v_mfma_f32_32x32x16_bf16 v[64:79], v[216:219], v[200:203], v[64:79]
    buffer_load_dwordx4 v196, s[12:15], s56 offen offset:1024 lds
    s_add_u32 s56, s56, 64
    ds_read_b128 v[208:211], v192 offset:24576
    ds_read_b64_tr_b16 v[216:217], v184 offset:24576
    ds_read_b64_tr_b16 v[218:219], v184 offset:25600
    s_waitcnt lgkmcnt(12)
    v_mfma_f32_32x32x16_bf16 v[80:95], v[220:223], v[200:203], v[80:95]
    ds_read_b64_tr_b16 v[220:221], v185 offset:24576
    ds_read_b64_tr_b16 v[222:223], v185 offset:25600
    s_waitcnt lgkmcnt(11)
    v_mfma_f32_32x32x16_bf16 v[32:47], v[16:19], v[204:207], v[32:47]
    ds_read_b64_tr_b16 v[16:17], v186 offset:24576
    ds_read_b64_tr_b16 v[18:19], v186 offset:25600
    s_waitcnt lgkmcnt(11)
    v_mfma_f32_32x32x16_bf16 v[48:63], v[20:23], v[204:207], v[48:63]
    ds_read_b64_tr_b16 v[20:21], v187 offset:24576
    ds_read_b64_tr_b16 v[22:23], v187 offset:25600
    s_waitcnt lgkmcnt(11)
    v_mfma_f32_32x32x16_bf16 v[64:79], v[24:27], v[204:207], v[64:79]
    ds_read_b128 v[212:215], v193 offset:24576
    ds_read_b64_tr_b16 v[24:25], v184 offset:28672
    ds_read_b64_tr_b16 v[26:27], v184 offset:29696
    s_waitcnt lgkmcnt(12)
    v_mfma_f32_32x32x16_bf16 v[80:95], v[28:31], v[204:207], v[80:95]
    s_waitcnt vmcnt(9)
    s_barrier
    ds_read_b64_tr_b16 v[28:29], v185 offset:28672
    ds_read_b64_tr_b16 v[30:31], v185 offset:29696
    s_waitcnt lgkmcnt(11)
    v_mfma_f32_32x32x16_bf16 v[32:47], v[216:219], v[208:211], v[32:47]
    s_add_u32 s9, s61, 98304
    s_mov_b32 m0, s9
    s_nop 0
    buffer_load_dwordx4 v3, s[16:19], s54 offen lds
    s_add_u32 s54, s54, 262144
    ds_read_b64_tr_b16 v[216:217], v186 offset:28672
    ds_read_b64_tr_b16 v[218:219], v186 offset:29696
    s_waitcnt lgkmcnt(11)
    v_mfma_f32_32x32x16_bf16 v[48:63], v[220:223], v[208:211], v[48:63]
    s_add_u32 s9, s60, 106496
    s_mov_b32 m0, s9
    s_nop 0
    buffer_load_dwordx4 v196, s[12:15], s55 offen lds
    s_add_u32 s55, s55, 64
    ds_read_b64_tr_b16 v[220:221], v187 offset:28672
    ds_read_b64_tr_b16 v[222:223], v187 offset:29696
    s_waitcnt lgkmcnt(11)
    v_mfma_f32_32x32x16_bf16 v[64:79], v[16:19], v[208:211], v[64:79]
    buffer_load_dwordx4 v196, s[12:15], s56 offen offset:1024 lds
    s_add_u32 s56, s56, 64
    ds_read_b128 v[200:203], v188
    ds_read_b64_tr_b16 v[16:17], v176
    ds_read_b64_tr_b16 v[18:19], v176 offset:1024
    s_waitcnt lgkmcnt(12)
    v_mfma_f32_32x32x16_bf16 v[80:95], v[20:23], v[208:211], v[80:95]
    ds_read_b64_tr_b16 v[20:21], v177
    ds_read_b64_tr_b16 v[22:23], v177 offset:1024
    s_waitcnt lgkmcnt(11)
    v_mfma_f32_32x32x16_bf16 v[32:47], v[24:27], v[212:215], v[32:47]
    ds_read_b64_tr_b16 v[24:25], v178
    ds_read_b64_tr_b16 v[26:27], v178 offset:1024
    s_waitcnt lgkmcnt(11)
    v_mfma_f32_32x32x16_bf16 v[48:63], v[28:31], v[212:215], v[48:63]
    ds_read_b64_tr_b16 v[28:29], v179
    ds_read_b64_tr_b16 v[30:31], v179 offset:1024
    s_waitcnt lgkmcnt(11)
    v_mfma_f32_32x32x16_bf16 v[64:79], v[216:219], v[212:215], v[64:79]
    ds_read_b128 v[204:207], v189
    ds_read_b64_tr_b16 v[216:217], v176 offset:4096
    ds_read_b64_tr_b16 v[218:219], v176 offset:5120
    s_waitcnt lgkmcnt(12)
    v_mfma_f32_32x32x16_bf16 v[80:95], v[220:223], v[212:215], v[80:95]
    s_waitcnt vmcnt(9)
    s_barrier
    ds_read_b64_tr_b16 v[220:221], v177 offset:4096
    ds_read_b64_tr_b16 v[222:223], v177 offset:5120
    s_waitcnt lgkmcnt(11)
    v_mfma_f32_32x32x16_bf16 v[32:47], v[16:19], v[200:203], v[32:47]
    s_add_u32 s9, s61, 122880
    s_mov_b32 m0, s9
    s_nop 0
    buffer_load_dwordx4 v3, s[16:19], s54 offen lds
    s_add_u32 s54, s54, 262144
    ds_read_b64_tr_b16 v[16:17], v178 offset:4096
    ds_read_b64_tr_b16 v[18:19], v178 offset:5120
    s_waitcnt lgkmcnt(11)
    v_mfma_f32_32x32x16_bf16 v[48:63], v[20:23], v[200:203], v[48:63]
    s_add_u32 s9, s60, 131072
    s_mov_b32 m0, s9
    s_nop 0
    buffer_load_dwordx4 v196, s[12:15], s55 offen lds
    s_add_u32 s55, s55, 64
    ds_read_b64_tr_b16 v[20:21], v179 offset:4096
    ds_read_b64_tr_b16 v[22:23], v179 offset:5120
    s_waitcnt lgkmcnt(11)
    v_mfma_f32_32x32x16_bf16 v[64:79], v[24:27], v[200:203], v[64:79]
    buffer_load_dwordx4 v196, s[12:15], s56 offen offset:1024 lds
    s_add_u32 s56, s56, 64
    ds_read_b128 v[208:211], v188 offset:24576
    ds_read_b64_tr_b16 v[24:25], v176 offset:24576
    ds_read_b64_tr_b16 v[26:27], v176 offset:25600
    s_waitcnt lgkmcnt(12)
    v_mfma_f32_32x32x16_bf16 v[80:95], v[28:31], v[200:203], v[80:95]
    ds_read_b64_tr_b16 v[28:29], v177 offset:24576
    ds_read_b64_tr_b16 v[30:31], v177 offset:25600
    s_waitcnt lgkmcnt(11)
    v_mfma_f32_32x32x16_bf16 v[32:47], v[216:219], v[204:207], v[32:47]
    ds_read_b64_tr_b16 v[216:217], v178 offset:24576
    ds_read_b64_tr_b16 v[218:219], v178 offset:25600
    s_waitcnt lgkmcnt(11)
    v_mfma_f32_32x32x16_bf16 v[48:63], v[220:223], v[204:207], v[48:63]
    ds_read_b64_tr_b16 v[220:221], v179 offset:24576
    ds_read_b64_tr_b16 v[222:223], v179 offset:25600
    s_waitcnt lgkmcnt(11)
    v_mfma_f32_32x32x16_bf16 v[64:79], v[16:19], v[204:207], v[64:79]
    ds_read_b128 v[212:215], v189 offset:24576
    ds_read_b64_tr_b16 v[16:17], v176 offset:28672
    ds_read_b64_tr_b16 v[18:19], v176 offset:29696
    s_waitcnt lgkmcnt(12)
    v_mfma_f32_32x32x16_bf16 v[80:95], v[20:23], v[204:207], v[80:95]
    s_waitcnt vmcnt(9)
    s_barrier
    ds_read_b64_tr_b16 v[20:21], v177 offset:28672
    ds_read_b64_tr_b16 v[22:23], v177 offset:29696
    s_waitcnt lgkmcnt(11)
    v_mfma_f32_32x32x16_bf16 v[32:47], v[24:27], v[208:211], v[32:47]
    s_add_u32 s9, s61, 0
    s_mov_b32 m0, s9
    s_nop 0
    buffer_load_dwordx4 v3, s[16:19], s54 offen lds
    s_add_u32 s54, s54, 262144
    ds_read_b64_tr_b16 v[24:25], v178 offset:28672
    ds_read_b64_tr_b16 v[26:27], v178 offset:29696
    s_waitcnt lgkmcnt(11)
    v_mfma_f32_32x32x16_bf16 v[48:63], v[28:31], v[208:211], v[48:63]
    s_add_u32 s9, s60, 8192
    s_mov_b32 m0, s9
    s_nop 0
    buffer_load_dwordx4 v196, s[12:15], s55 offen lds
    s_add_u32 s55, s55, 64
    ds_read_b64_tr_b16 v[28:29], v179 offset:28672
    ds_read_b64_tr_b16 v[30:31], v179 offset:29696
    s_waitcnt lgkmcnt(11)
    v_mfma_f32_32x32x16_bf16 v[64:79], v[216:219], v[208:211], v[64:79]
    buffer_load_dwordx4 v196, s[12:15], s56 offen offset:1024 lds
    s_add_u32 s56, s56, 64
    ds_read_b128 v[200:203], v190
    ds_read_b64_tr_b16 v[216:217], v180
    ds_read_b64_tr_b16 v[218:219], v180 offset:1024
    s_waitcnt lgkmcnt(12)
    v_mfma_f32_32x32x16_bf16 v[80:95], v[220:223], v[208:211], v[80:95]
    ds_read_b64_tr_b16 v[220:221], v181
    ds_read_b64_tr_b16 v[222:223], v181 offset:1024
    s_waitcnt lgkmcnt(11)
    v_mfma_f32_32x32x16_bf16 v[32:47], v[16:19], v[212:215], v[32:47]
    ds_read_b64_tr_b16 v[16:17], v182
    ds_read_b64_tr_b16 v[18:19], v182 offset:1024
    s_waitcnt lgkmcnt(11)
    v_mfma_f32_32x32x16_bf16 v[48:63], v[20:23], v[212:215], v[48:63]
    ds_read_b64_tr_b16 v[20:21], v183
    ds_read_b64_tr_b16 v[22:23], v183 offset:1024
    s_waitcnt lgkmcnt(11)
    v_mfma_f32_32x32x16_bf16 v[64:79], v[24:27], v[212:215], v[64:79]
    ds_read_b128 v[204:207], v191
    ds_read_b64_tr_b16 v[24:25], v180 offset:4096
    ds_read_b64_tr_b16 v[26:27], v180 offset:5120
    s_waitcnt lgkmcnt(12)
    v_mfma_f32_32x32x16_bf16 v[80:95], v[28:31], v[212:215], v[80:95]
    s_waitcnt vmcnt(9)
    s_barrier
    ds_read_b64_tr_b16 v[28:29], v181 offset:4096
    ds_read_b64_tr_b16 v[30:31], v181 offset:5120
    s_waitcnt lgkmcnt(11)
    v_mfma_f32_32x32x16_bf16 v[32:47], v[216:219], v[200:203], v[32:47]
    s_add_u32 s9, s61, 24576
    s_mov_b32 m0, s9
    s_nop 0
    buffer_load_dwordx4 v3, s[16:19], s54 offen lds
    s_add_u32 s54, s54, 262144
    ds_read_b64_tr_b16 v[216:217], v182 offset:4096
    ds_read_b64_tr_b16 v[218:219], v182 offset:5120
    s_waitcnt lgkmcnt(11)
    v_mfma_f32_32x32x16_bf16 v[48:63], v[220:223], v[200:203], v[48:63]
    s_add_u32 s9, s60, 32768
    s_mov_b32 m0, s9
    s_nop 0
    buffer_load_dwordx4 v196, s[12:15], s55 offen lds
    s_add_u32 s55, s55, 64
    ds_read_b64_tr_b16 v[220:221], v183 offset:4096
    ds_read_b64_tr_b16 v[222:223], v183 offset:5120
    s_waitcnt lgkmcnt(11)
    v_mfma_f32_32x32x16_bf16 v[64:79], v[16:19], v[200:203], v[64:79]
    buffer_load_dwordx4 v196, s[12:15], s56 offen offset:1024 lds
    s_add_u32 s56, s56, 64
    ds_read_b128 v[208:211], v190 offset:24576
    ds_read_b64_tr_b16 v[16:17], v180 offset:24576
    ds_read_b64_tr_b16 v[18:19], v180 offset:25600
    s_waitcnt lgkmcnt(12)
    v_mfma_f32_32x32x16_bf16 v[80:95], v[20:23], v[200:203], v[80:95]
    ds_read_b64_tr_b16 v[20:21], v181 offset:24576
    ds_read_b64_tr_b16 v[22:23], v181 offset:25600
    s_waitcnt lgkmcnt(11)
    v_mfma_f32_32x32x16_bf16 v[32:47], v[24:27], v[204:207], v[32:47]
    ds_read_b64_tr_b16 v[24:25], v182 offset:24576
    ds_read_b64_tr_b16 v[26:27], v182 offset:25600
    s_waitcnt lgkmcnt(11)
    v_mfma_f32_32x32x16_bf16 v[48:63], v[28:31], v[204:207], v[48:63]
    ds_read_b64_tr_b16 v[28:29], v183 offset:24576
    ds_read_b64_tr_b16 v[30:31], v183 offset:25600
    s_waitcnt lgkmcnt(11)
    v_mfma_f32_32x32x16_bf16 v[64:79], v[216:219], v[204:207], v[64:79]
    ds_read_b128 v[212:215], v191 offset:24576
    ds_read_b64_tr_b16 v[216:217], v180 offset:28672
    ds_read_b64_tr_b16 v[218:219], v180 offset:29696
    s_waitcnt lgkmcnt(12)
    v_mfma_f32_32x32x16_bf16 v[80:95], v[220:223], v[204:207], v[80:95]
    s_waitcnt vmcnt(9)
    s_barrier
    ds_read_b64_tr_b16 v[220:221], v181 offset:28672
    ds_read_b64_tr_b16 v[222:223], v181 offset:29696
    s_waitcnt lgkmcnt(11)
    v_mfma_f32_32x32x16_bf16 v[32:47], v[16:19], v[208:211], v[32:47]
    s_add_u32 s78, s71, 0
    s_add_u32 s78, s78, s77
    s_mov_b32 m0, s78
    s_add_u32 s78, s79, 0
    ds_read_b64_tr_b16 v[16:17], v182 offset:28672
    ds_read_b64_tr_b16 v[18:19], v182 offset:29696
    s_waitcnt lgkmcnt(11)
    v_mfma_f32_32x32x16_bf16 v[48:63], v[20:23], v[208:211], v[48:63]
    buffer_load_dwordx4 v4, s[20:23], s78 offen nt lds
    ds_read_b64_tr_b16 v[20:21], v183 offset:28672
    ds_read_b64_tr_b16 v[22:23], v183 offset:29696
    s_waitcnt lgkmcnt(11)
    v_mfma_f32_32x32x16_bf16 v[64:79], v[24:27], v[208:211], v[64:79]
    buffer_load_dwordx4 v5, s[20:23], s78 offen offset:1024 nt lds
    ds_read_b128 v[200:203], v192
    ds_read_b64_tr_b16 v[24:25], v184
    ds_read_b64_tr_b16 v[26:27], v184 offset:1024
    s_waitcnt lgkmcnt(12)
    v_mfma_f32_32x32x16_bf16 v[80:95], v[28:31], v[208:211], v[80:95]
    buffer_load_dwordx4 v6, s[20:23], s78 offen offset:2048 nt lds
    ds_read_b64_tr_b16 v[28:29], v185
    ds_read_b64_tr_b16 v[30:31], v185 offset:1024
    s_waitcnt lgkmcnt(11)
    v_mfma_f32_32x32x16_bf16 v[32:47], v[216:219], v[212:215], v[32:47]
    buffer_load_dwordx4 v7, s[20:23], s78 offen offset:3072 nt lds
    ds_read_b64_tr_b16 v[216:217], v186
    ds_read_b64_tr_b16 v[218:219], v186 offset:1024
    s_waitcnt lgkmcnt(11)
    v_mfma_f32_32x32x16_bf16 v[48:63], v[220:223], v[212:215], v[48:63]
    ds_read_b64_tr_b16 v[220:221], v187
    ds_read_b64_tr_b16 v[222:223], v187 offset:1024
    s_waitcnt lgkmcnt(11)
    v_mfma_f32_32x32x16_bf16 v[64:79], v[16:19], v[212:215], v[64:79]
    ds_read_b128 v[204:207], v193
    ds_read_b64_tr_b16 v[16:17], v184 offset:4096
    ds_read_b64_tr_b16 v[18:19], v184 offset:5120
    s_waitcnt lgkmcnt(12)
    v_mfma_f32_32x32x16_bf16 v[80:95], v[20:23], v[212:215], v[80:95]
    s_waitcnt vmcnt(10)
    s_barrier
    ds_read_b64_tr_b16 v[20:21], v185 offset:4096
    ds_read_b64_tr_b16 v[22:23], v185 offset:5120
    s_waitcnt lgkmcnt(11)
    v_mfma_f32_32x32x16_bf16 v[32:47], v[24:27], v[200:203], v[32:47]
    s_add_u32 s78, s71, 16384
    s_cmp_ge_u32 s78, 81920
    s_cselect_b32 s10, 81920, 0
    s_sub_u32 s78, s78, s10
    s_add_u32 s78, s78, s77
    s_mov_b32 m0, s78
    s_add_u32 s78, s79, 16384
    ds_read_b64_tr_b16 v[24:25], v186 offset:4096
    ds_read_b64_tr_b16 v[26:27], v186 offset:5120
    s_waitcnt lgkmcnt(11)
    v_mfma_f32_32x32x16_bf16 v[48:63], v[28:31], v[200:203], v[48:63]
    buffer_load_dwordx4 v4, s[20:23], s78 offen nt lds
    ds_read_b64_tr_b16 v[28:29], v187 offset:4096
    ds_read_b64_tr_b16 v[30:31], v187 offset:5120
    s_waitcnt lgkmcnt(11)
    v_mfma_f32_32x32x16_bf16 v[64:79], v[216:219], v[200:203], v[64:79]
    buffer_load_dwordx4 v5, s[20:23], s78 offen offset:1024 nt lds
    ds_read_b128 v[208:211], v192 offset:24576
    ds_read_b64_tr_b16 v[216:217], v184 offset:24576
    ds_read_b64_tr_b16 v[218:219], v184 offset:25600
    s_waitcnt lgkmcnt(12)
    v_mfma_f32_32x32x16_bf16 v[80:95], v[220:223], v[200:203], v[80:95]
    buffer_load_dwordx4 v6, s[20:23], s78 offen offset:2048 nt lds
    ds_read_b64_tr_b16 v[220:221], v185 offset:24576
    ds_read_b64_tr_b16 v[222:223], v185 offset:25600
    s_waitcnt lgkmcnt(11)
    v_mfma_f32_32x32x16_bf16 v[32:47], v[16:19], v[204:207], v[32:47]
    buffer_load_dwordx4 v7, s[20:23], s78 offen offset:3072 nt lds
    ds_read_b64_tr_b16 v[16:17], v186 offset:24576
    ds_read_b64_tr_b16 v[18:19], v186 offset:25600
    s_waitcnt lgkmcnt(11)
    v_mfma_f32_32x32x16_bf16 v[48:63], v[20:23], v[204:207], v[48:63]
    ds_read_b64_tr_b16 v[20:21], v187 offset:24576
    ds_read_b64_tr_b16 v[22:23], v187 offset:25600
    s_waitcnt lgkmcnt(11)
    v_mfma_f32_32x32x16_bf16 v[64:79], v[24:27], v[204:207], v[64:79]
    ds_read_b128 v[212:215], v193 offset:24576
    ds_read_b64_tr_b16 v[24:25], v184 offset:28672
    ds_read_b64_tr_b16 v[26:27], v184 offset:29696
    s_waitcnt lgkmcnt(12)
    v_mfma_f32_32x32x16_bf16 v[80:95], v[28:31], v[204:207], v[80:95]
    s_waitcnt vmcnt(11)
    s_barrier
    ds_read_b64_tr_b16 v[28:29], v185 offset:28672
    ds_read_b64_tr_b16 v[30:31], v185 offset:29696
    s_waitcnt lgkmcnt(11)
    v_mfma_f32_32x32x16_bf16 v[32:47], v[216:219], v[208:211], v[32:47]
    ds_read_b64_tr_b16 v[216:217], v186 offset:28672
    ds_read_b64_tr_b16 v[218:219], v186 offset:29696
    s_waitcnt lgkmcnt(11)
    v_mfma_f32_32x32x16_bf16 v[48:63], v[220:223], v[208:211], v[48:63]
    ds_read_b64_tr_b16 v[220:221], v187 offset:28672
    ds_read_b64_tr_b16 v[222:223], v187 offset:29696
    s_waitcnt lgkmcnt(11)
    v_mfma_f32_32x32x16_bf16 v[64:79], v[16:19], v[208:211], v[64:79]
    ds_read_b128 v[200:203], v188
    ds_read_b64_tr_b16 v[16:17], v176
    ds_read_b64_tr_b16 v[18:19], v176 offset:1024
    s_waitcnt lgkmcnt(12)
    v_mfma_f32_32x32x16_bf16 v[80:95], v[20:23], v[208:211], v[80:95]
    ds_read_b64_tr_b16 v[20:21], v177
    ds_read_b64_tr_b16 v[22:23], v177 offset:1024
    s_waitcnt lgkmcnt(11)
    v_mfma_f32_32x32x16_bf16 v[32:47], v[24:27], v[212:215], v[32:47]
    ds_read_b64_tr_b16 v[24:25], v178
    ds_read_b64_tr_b16 v[26:27], v178 offset:1024
    s_waitcnt lgkmcnt(11)
    v_mfma_f32_32x32x16_bf16 v[48:63], v[28:31], v[212:215], v[48:63]
    ds_read_b64_tr_b16 v[28:29], v179
    ds_read_b64_tr_b16 v[30:31], v179 offset:1024
    s_waitcnt lgkmcnt(11)
    v_mfma_f32_32x32x16_bf16 v[64:79], v[216:219], v[212:215], v[64:79]
    ds_read_b128 v[204:207], v189
    ds_read_b64_tr_b16 v[216:217], v176 offset:4096
    ds_read_b64_tr_b16 v[218:219], v176 offset:5120
    s_waitcnt lgkmcnt(12)
    v_mfma_f32_32x32x16_bf16 v[80:95], v[220:223], v[212:215], v[80:95]
    s_waitcnt vmcnt(8)
    s_barrier
    ds_read_b64_tr_b16 v[220:221], v177 offset:4096
    ds_read_b64_tr_b16 v[222:223], v177 offset:5120
    s_waitcnt lgkmcnt(11)
    v_mfma_f32_32x32x16_bf16 v[32:47], v[16:19], v[200:203], v[32:47]
    ds_read_b64_tr_b16 v[16:17], v178 offset:4096
    ds_read_b64_tr_b16 v[18:19], v178 offset:5120
    s_waitcnt lgkmcnt(11)
    v_mfma_f32_32x32x16_bf16 v[48:63], v[20:23], v[200:203], v[48:63]
    ds_read_b64_tr_b16 v[20:21], v179 offset:4096
    ds_read_b64_tr_b16 v[22:23], v179 offset:5120
    s_waitcnt lgkmcnt(11)
    v_mfma_f32_32x32x16_bf16 v[64:79], v[24:27], v[200:203], v[64:79]
    ds_read_b128 v[208:211], v188 offset:24576
    ds_read_b64_tr_b16 v[24:25], v176 offset:24576
    ds_read_b64_tr_b16 v[26:27], v176 offset:25600
    s_waitcnt lgkmcnt(12)
    v_mfma_f32_32x32x16_bf16 v[80:95], v[28:31], v[200:203], v[80:95]
    ds_read_b64_tr_b16 v[28:29], v177 offset:24576
    ds_read_b64_tr_b16 v[30:31], v177 offset:25600
    s_waitcnt lgkmcnt(11)
    v_mfma_f32_32x32x16_bf16 v[32:47], v[216:219], v[204:207], v[32:47]
    ds_read_b64_tr_b16 v[216:217], v178 offset:24576
    ds_read_b64_tr_b16 v[218:219], v178 offset:25600
    s_waitcnt lgkmcnt(11)
    v_mfma_f32_32x32x16_bf16 v[48:63], v[220:223], v[204:207], v[48:63]
    ds_read_b64_tr_b16 v[220:221], v179 offset:24576
    ds_read_b64_tr_b16 v[222:223], v179 offset:25600
    s_waitcnt lgkmcnt(11)
    v_mfma_f32_32x32x16_bf16 v[64:79], v[16:19], v[204:207], v[64:79]
    ds_read_b128 v[212:215], v189 offset:24576
    ds_read_b64_tr_b16 v[16:17], v176 offset:28672
    ds_read_b64_tr_b16 v[18:19], v176 offset:29696
    s_waitcnt lgkmcnt(12)
    v_mfma_f32_32x32x16_bf16 v[80:95], v[20:23], v[204:207], v[80:95]
    s_barrier
    ds_read_b64_tr_b16 v[20:21], v177 offset:28672
    ds_read_b64_tr_b16 v[22:23], v177 offset:29696
    s_waitcnt lgkmcnt(11)
    v_mfma_f32_32x32x16_bf16 v[32:47], v[24:27], v[208:211], v[32:47]
    s_add_u32 s78, s71, 32768
    s_cmp_ge_u32 s78, 81920
    s_cselect_b32 s10, 81920, 0
    s_sub_u32 s78, s78, s10
    s_add_u32 s78, s78, s77
    s_mov_b32 m0, s78
    s_add_u32 s78, s79, 0
    ds_read_b64_tr_b16 v[24:25], v178 offset:28672
    ds_read_b64_tr_b16 v[26:27], v178 offset:29696
    s_waitcnt lgkmcnt(11)
    v_mfma_f32_32x32x16_bf16 v[48:63], v[28:31], v[208:211], v[48:63]
    buffer_load_dwordx4 v2, s[24:27], s78 offen nt lds
    ds_read_b64_tr_b16 v[28:29], v179 offset:28672
    ds_read_b64_tr_b16 v[30:31], v179 offset:29696
    s_waitcnt lgkmcnt(11)
    v_mfma_f32_32x32x16_bf16 v[64:79], v[216:219], v[208:211], v[64:79]
    buffer_load_dwordx4 v2, s[24:27], s78 offen offset:1024 nt lds
    s_waitcnt lgkmcnt(9)
    v_mfma_f32_32x32x16_bf16 v[80:95], v[220:223], v[208:211], v[80:95]
    buffer_load_dwordx4 v2, s[24:27], s78 offen offset:2048 nt lds
    s_waitcnt lgkmcnt(6)
    v_mfma_f32_32x32x16_bf16 v[32:47], v[16:19], v[212:215], v[32:47]
    buffer_load_dwordx4 v2, s[24:27], s78 offen offset:3072 nt lds
    s_waitcnt lgkmcnt(4)
    v_mfma_f32_32x32x16_bf16 v[48:63], v[20:23], v[212:215], v[48:63]
    s_waitcnt lgkmcnt(2)
    v_mfma_f32_32x32x16_bf16 v[64:79], v[24:27], v[212:215], v[64:79]
    s_waitcnt lgkmcnt(0)
    v_mfma_f32_32x32x16_bf16 v[80:95], v[28:31], v[212:215], v[80:95]
    s_barrier
    s_add_u32 s78, s71, 49152
    s_cmp_ge_u32 s78, 81920
    s_cselect_b32 s10, 81920, 0
    s_sub_u32 s78, s78, s10
    s_add_u32 s78, s78, s77
    s_mov_b32 m0, s78
    s_add_u32 s78, s79, 16384
    buffer_load_dwordx4 v2, s[24:27], s78 offen nt lds
    buffer_load_dwordx4 v2, s[24:27], s78 offen offset:1024 nt lds
    buffer_load_dwordx4 v2, s[24:27], s78 offen offset:2048 nt lds
    buffer_load_dwordx4 v2, s[24:27], s78 offen offset:3072 nt lds
    s_add_u32 s78, s71, 65536
    s_cmp_ge_u32 s78, 81920
    s_cselect_b32 s10, 81920, 0
    s_sub_u32 s78, s78, s10
    s_add_u32 s78, s78, s77
    s_mov_b32 m0, s78
    s_add_u32 s78, s79, 32768
    buffer_load_dwordx4 v4, s[20:23], s78 offen nt lds
    buffer_load_dwordx4 v5, s[20:23], s78 offen offset:1024 nt lds
    buffer_load_dwordx4 v6, s[20:23], s78 offen offset:2048 nt lds
    buffer_load_dwordx4 v7, s[20:23], s78 offen offset:3072 nt lds
    v_cvt_pk_bf16_f32 v224, v32, v33
    v_cvt_pk_bf16_f32 v225, v34, v35
    v_cvt_pk_bf16_f32 v226, v36, v37
    v_cvt_pk_bf16_f32 v227, v38, v39
    v_cvt_pk_bf16_f32 v228, v40, v41
    v_cvt_pk_bf16_f32 v229, v42, v43
    v_cvt_pk_bf16_f32 v230, v44, v45
    v_cvt_pk_bf16_f32 v231, v46, v47
    v_cvt_pk_bf16_f32 v232, v48, v49
    v_cvt_pk_bf16_f32 v233, v50, v51
    v_cvt_pk_bf16_f32 v234, v52, v53
    v_cvt_pk_bf16_f32 v235, v54, v55
    v_cvt_pk_bf16_f32 v236, v56, v57
    v_cvt_pk_bf16_f32 v237, v58, v59
    v_cvt_pk_bf16_f32 v238, v60, v61
    v_cvt_pk_bf16_f32 v239, v62, v63
    v_cvt_pk_bf16_f32 v240, v64, v65
    v_cvt_pk_bf16_f32 v241, v66, v67
    v_cvt_pk_bf16_f32 v242, v68, v69
    v_cvt_pk_bf16_f32 v243, v70, v71
    v_cvt_pk_bf16_f32 v244, v72, v73
    v_cvt_pk_bf16_f32 v245, v74, v75
    v_cvt_pk_bf16_f32 v246, v76, v77
    v_cvt_pk_bf16_f32 v247, v78, v79
    v_cvt_pk_bf16_f32 v248, v80, v81
    v_cvt_pk_bf16_f32 v249, v82, v83
    v_cvt_pk_bf16_f32 v250, v84, v85
    v_cvt_pk_bf16_f32 v251, v86, v87
    v_cvt_pk_bf16_f32 v252, v88, v89
    v_cvt_pk_bf16_f32 v253, v90, v91
    v_cvt_pk_bf16_f32 v254, v92, v93
    v_cvt_pk_bf16_f32 v255, v94, v95
    s_waitcnt vmcnt(12)
    s_branch L_join
L_grpB:
    s_lshl_b32 s79, s5, 12
    s_add_u32 s78, s79, 0
    buffer_load_dwordx4 v[96:99], v4, s[20:23], s78 offen nt
    buffer_load_dwordx4 v[100:103], v5, s[20:23], s78 offen offset:1024 nt
    buffer_load_dwordx4 v[104:107], v6, s[20:23], s78 offen offset:2048 nt
    buffer_load_dwordx4 v[108:111], v7, s[20:23], s78 offen offset:3072 nt
    s_add_u32 s78, s79, 16384
    buffer_load_dwordx4 v[112:115], v4, s[20:23], s78 offen nt
    buffer_load_dwordx4 v[116:119], v5, s[20:23], s78 offen offset:1024 nt
    buffer_load_dwordx4 v[120:123], v6, s[20:23], s78 offen offset:2048 nt
    buffer_load_dwordx4 v[124:127], v7, s[20:23], s78 offen offset:3072 nt
    s_add_u32 s78, s79, 0
    buffer_load_dwordx4 v[128:131], v2, s[24:27], s78 offen nt
    buffer_load_dwordx4 v[132:135], v2, s[24:27], s78 offen offset:1024 nt
    buffer_load_dwordx4 v[136:139], v2, s[24:27], s78 offen offset:2048 nt
    buffer_load_dwordx4 v[140:143], v2, s[24:27], s78 offen offset:3072 nt
    v_lshlrev_b32 v197, 4, v1
    v_add_u32 v197, s77, v197
    s_add_u32 s9, s61, 0
    s_mov_b32 m0, s9
    s_nop 0
    buffer_load_dwordx4 v3, s[16:19], s54 offen lds
    s_add_u32 s54, s54, 262144
    s_add_u32 s9, s60, 8192
    s_mov_b32 m0, s9
    s_nop 0
    buffer_load_dwordx4 v196, s[12:15], s55 offen lds
    s_add_u32 s55, s55, 64
    buffer_load_dwordx4 v196, s[12:15], s56 offen offset:1024 lds
    s_add_u32 s56, s56, 64
    s_add_u32 s9, s61, 24576
    s_mov_b32 m0, s9
    s_nop 0
    buffer_load_dwordx4 v3, s[16:19], s54 offen lds
    s_add_u32 s54, s54, 262144
    s_add_u32 s9, s60, 32768
    s_mov_b32 m0, s9
    s_nop 0
    buffer_load_dwordx4 v196, s[12:15], s55 offen lds
    s_add_u32 s55, s55, 64
    buffer_load_dwordx4 v196, s[12:15], s56 offen offset:1024 lds
    s_add_u32 s56, s56, 64
    s_add_u32 s9, s61, 49152
    s_mov_b32 m0, s9
    s_nop 0
    buffer_load_dwordx4 v3, s[16:19], s54 offen lds
    s_add_u32 s54, s54, 262144
    s_add_u32 s9, s60, 57344
    s_mov_b32 m0, s9
    s_nop 0
    buffer_load_dwordx4 v196, s[12:15], s55 offen lds
    s_add_u32 s55, s55, 64
    buffer_load_dwordx4 v196, s[12:15], s56 offen offset:1024 lds
    s_add_u32 s56, s56, 64
    s_waitcnt vmcnt(3)
    s_barrier
    ds_read_b128 v[200:203], v188
    ds_read_b64_tr_b16 v[16:17], v176
    ds_read_b64_tr_b16 v[18:19], v176 offset:1024
    ds_read_b64_tr_b16 v[20:21], v177
    ds_read_b64_tr_b16 v[22:23], v177 offset:1024
    ds_read_b64_tr_b16 v[24:25], v178
    ds_read_b64_tr_b16 v[26:27], v178 offset:1024
    ds_read_b64_tr_b16 v[28:29], v179
    ds_read_b64_tr_b16 v[30:31], v179 offset:1024
    ds_read_b128 v[204:207], v189
    ds_read_b64_tr_b16 v[216:217], v176 offset:4096
    ds_read_b64_tr_b16 v[218:219], v176 offset:5120
    ds_read_b64_tr_b16 v[220:221], v177 offset:4096
    ds_read_b64_tr_b16 v[222:223], v177 offset:5120
    s_waitcnt lgkmcnt(11)
    v_mfma_f32_32x32x16_bf16 v[32:47], v[16:19], v[200:203], 0
    s_add_u32 s9, s61, 73728
    s_mov_b32 m0, s9
    s_nop 0
    buffer_load_dwordx4 v3, s[16:19], s54 offen lds
    s_add_u32 s54, s54, 262144
    ds_read_b64_tr_b16 v[16:17], v178 offset:4096
    ds_read_b64_tr_b16 v[18:19], v178 offset:5120
    s_waitcnt lgkmcnt(11)
    v_mfma_f32_32x32x16_bf16 v[48:63], v[20:23], v[200:203], 0
    s_add_u32 s9, s60, 81920
    s_mov_b32 m0, s9
    s_nop 0
    buffer_load_dwordx4 v196, s[12:15], s55 offen lds
    s_add_u32 s55, s55, 64
    ds_read_b64_tr_b16 v[20:21], v179 offset:4096
    ds_read_b64_tr_b16 v[22:23], v179 offset:5120
    s_waitcnt lgkmcnt(11)
    v_mfma_f32_32x32x16_bf16 v[64:79], v[24:27], v[200:203], 0
    buffer_load_dwordx4 v196, s[12:15], s56 offen offset:1024 lds
    s_add_u32 s56, s56, 64
    ds_read_b128 v[208:211], v188 offset:24576
    ds_read_b64_tr_b16 v[24:25], v176 offset:24576
    ds_read_b64_tr_b16 v[26:27], v176 offset:25600
    s_waitcnt lgkmcnt(12)
    v_mfma_f32_32x32x16_bf16 v[80:95], v[28:31], v[200:203], 0
    s_add_u32 s9, s61, 98304
    s_mov_b32 m0, s9
    s_nop 0
    buffer_load_dwordx4 v3, s[16:19], s54 offen lds
    s_add_u32 s54, s54, 262144
    ds_read_b64_tr_b16 v[28:29], v177 offset:24576
    ds_read_b64_tr_b16 v[30:31], v177 offset:25600
    s_waitcnt lgkmcnt(11)
    v_mfma_f32_32x32x16_bf16 v[32:47], v[216:219], v[204:207], v[32:47]
    s_add_u32 s9, s60, 106496
    s_mov_b32 m0, s9
    s_nop 0
    buffer_load_dwordx4 v196, s[12:15], s55 offen lds
    s_add_u32 s55, s55, 64
    ds_read_b64_tr_b16 v[216:217], v178 offset:24576
    ds_read_b64_tr_b16 v[218:219], v178 offset:25600
    s_waitcnt lgkmcnt(11)
    v_mfma_f32_32x32x16_bf16 v[48:63], v[220:223], v[204:207], v[48:63]
    buffer_load_dwordx4 v196, s[12:15], s56 offen offset:1024 lds
    s_add_u32 s56, s56, 64
    ds_read_b64_tr_b16 v[220:221], v179 offset:24576
    ds_read_b64_tr_b16 v[222:223], v179 offset:25600
    s_waitcnt lgkmcnt(11)
    v_mfma_f32_32x32x16_bf16 v[64:79], v[16:19], v[204:207], v[64:79]
    ds_read_b128 v[212:215], v189 offset:24576
    ds_read_b64_tr_b16 v[16:17], v176 offset:28672
    ds_read_b64_tr_b16 v[18:19], v176 offset:29696
    s_waitcnt lgkmcnt(12)
    v_mfma_f32_32x32x16_bf16 v[80:95], v[20:23], v[204:207], v[80:95]
    s_waitcnt vmcnt(6)
    s_barrier
    ds_read_b64_tr_b16 v[20:21], v177 offset:28672
    ds_read_b64_tr_b16 v[22:23], v177 offset:29696
    s_waitcnt lgkmcnt(11)
    v_mfma_f32_32x32x16_bf16 v[32:47], v[24:27], v[208:211], v[32:47]
    s_add_u32 s9, s61, 122880
    s_mov_b32 m0, s9
    s_nop 0
    buffer_load_dwordx4 v3, s[16:19], s54 offen lds
    s_add_u32 s54, s54, 262144
    ds_read_b64_tr_b16 v[24:25], v178 offset:28672
    ds_read_b64_tr_b16 v[26:27], v178 offset:29696
    s_waitcnt lgkmcnt(11)
    v_mfma_f32_32x32x16_bf16 v[48:63], v[28:31], v[208:211], v[48:63]
    s_add_u32 s9, s60, 131072
    s_mov_b32 m0, s9
    s_nop 0
    buffer_load_dwordx4 v196, s[12:15], s55 offen lds
    s_add_u32 s55, s55, 64
    ds_read_b64_tr_b16 v[28:29], v179 offset:28672
    ds_read_b64_tr_b16 v[30:31], v179 offset:29696
    s_waitcnt lgkmcnt(11)
    v_mfma_f32_32x32x16_bf16 v[64:79], v[216:219], v[208:211], v[64:79]
    buffer_load_dwordx4 v196, s[12:15], s56 offen offset:1024 lds
    s_add_u32 s56, s56, 64
    ds_read_b128 v[200:203], v190
    ds_read_b64_tr_b16 v[216:217], v180
    ds_read_b64_tr_b16 v[218:219], v180 offset:1024
    s_waitcnt lgkmcnt(12)
    v_mfma_f32_32x32x16_bf16 v[80:95], v[220:223], v[208:211], v[80:95]
    s_add_u32 s9, s61, 0
    s_mov_b32 m0, s9
    s_nop 0
    buffer_load_dwordx4 v3, s[16:19], s54 offen lds
    s_add_u32 s54, s54, 262144
    ds_read_b64_tr_b16 v[220:221], v181
    ds_read_b64_tr_b16 v[222:223], v181 offset:1024
    s_waitcnt lgkmcnt(11)
    v_mfma_f32_32x32x16_bf16 v[32:47], v[16:19], v[212:215], v[32:47]
    s_add_u32 s9, s60, 8192
    s_mov_b32 m0, s9
    s_nop 0
    buffer_load_dwordx4 v196, s[12:15], s55 offen lds
    s_add_u32 s55, s55, 64
    ds_read_b64_tr_b16 v[16:17], v182
    ds_read_b64_tr_b16 v[18:19], v182 offset:1024
    s_waitcnt lgkmcnt(11)
    v_mfma_f32_32x32x16_bf16 v[48:63], v[20:23], v[212:215], v[48:63]
    buffer_load_dwordx4 v196, s[12:15], s56 offen offset:1024 lds
    s_add_u32 s56, s56, 64
    ds_read_b64_tr_b16 v[20:21], v183
    ds_read_b64_tr_b16 v[22:23], v183 offset:1024
    s_waitcnt lgkmcnt(11)
    v_mfma_f32_32x32x16_bf16 v[64:79], v[24:27], v[212:215], v[64:79]
    ds_read_b128 v[204:207], v191
    ds_read_b64_tr_b16 v[24:25], v180 offset:4096
    ds_read_b64_tr_b16 v[26:27], v180 offset:5120
    s_waitcnt lgkmcnt(12)
    v_mfma_f32_32x32x16_bf16 v[80:95], v[28:31], v[212:215], v[80:95]
    s_waitcnt vmcnt(9)
    s_barrier
    ds_read_b64_tr_b16 v[28:29], v181 offset:4096
    ds_read_b64_tr_b16 v[30:31], v181 offset:5120
    s_waitcnt lgkmcnt(11)
    v_mfma_f32_32x32x16_bf16 v[32:47], v[216:219], v[200:203], v[32:47]
    s_add_u32 s9, s61, 24576
    s_mov_b32 m0, s9
    s_nop 0
    buffer_load_dwordx4 v3, s[16:19], s54 offen lds
    s_add_u32 s54, s54, 262144
    ds_read_b64_tr_b16 v[216:217], v182 offset:4096
    ds_read_b64_tr_b16 v[218:219], v182 offset:5120
    s_waitcnt lgkmcnt(11)
    v_mfma_f32_32x32x16_bf16 v[48:63], v[220:223], v[200:203], v[48:63]
    s_add_u32 s9, s60, 32768
    s_mov_b32 m0, s9
    s_nop 0
    buffer_load_dwordx4 v196, s[12:15], s55 offen lds
    s_add_u32 s55, s55, 64
    ds_read_b64_tr_b16 v[220:221], v183 offset:4096
    ds_read_b64_tr_b16 v[222:223], v183 offset:5120
    s_waitcnt lgkmcnt(11)
    v_mfma_f32_32x32x16_bf16 v[64:79], v[16:19], v[200:203], v[64:79]
    buffer_load_dwordx4 v196, s[12:15], s56 offen offset:1024 lds
    s_add_u32 s56, s56, 64
    ds_read_b128 v[208:211], v190 offset:24576
    ds_read_b64_tr_b16 v[16:17], v180 offset:24576
    ds_read_b64_tr_b16 v[18:19], v180 offset:25600
    s_waitcnt lgkmcnt(12)
    v_mfma_f32_32x32x16_bf16 v[80:95], v[20:23], v[200:203], v[80:95]
    ds_read_b64_tr_b16 v[20:21], v181 offset:24576
    ds_read_b64_tr_b16 v[22:23], v181 offset:25600
    s_waitcnt lgkmcnt(11)
    v_mfma_f32_32x32x16_bf16 v[32:47], v[24:27], v[204:207], v[32:47]
    ds_read_b64_tr_b16 v[24:25], v182 offset:24576
    ds_read_b64_tr_b16 v[26:27], v182 offset:25600
    s_waitcnt lgkmcnt(11)
    v_mfma_f32_32x32x16_bf16 v[48:63], v[28:31], v[204:207], v[48:63]
    ds_read_b64_tr_b16 v[28:29], v183 offset:24576
    ds_read_b64_tr_b16 v[30:31], v183 offset:25600
    s_waitcnt lgkmcnt(11)
    v_mfma_f32_32x32x16_bf16 v[64:79], v[216:219], v[204:207], v[64:79]
    ds_read_b128 v[212:215], v191 offset:24576
    ds_read_b64_tr_b16 v[216:217], v180 offset:28672
    ds_read_b64_tr_b16 v[218:219], v180 offset:29696
    s_waitcnt lgkmcnt(12)
    v_mfma_f32_32x32x16_bf16 v[80:95], v[220:223], v[204:207], v[80:95]
    s_waitcnt vmcnt(9)
    s_barrier
    ds_read_b64_tr_b16 v[220:221], v181 offset:28672
    ds_read_b64_tr_b16 v[222:223], v181 offset:29696
    s_waitcnt lgkmcnt(11)
    v_mfma_f32_32x32x16_bf16 v[32:47], v[16:19], v[208:211], v[32:47]
    s_add_u32 s9, s61, 49152
    s_mov_b32 m0, s9
    s_nop 0
    buffer_load_dwordx4 v3, s[16:19], s54 offen lds
    s_add_u32 s54, s54, 262144
    ds_read_b64_tr_b16 v[16:17], v182 offset:28672
    ds_read_b64_tr_b16 v[18:19], v182 offset:29696
    s_waitcnt lgkmcnt(11)
    v_mfma_f32_32x32x16_bf16 v[48:63], v[20:23], v[208:211], v[48:63]
    s_add_u32 s9, s60, 57344
    s_mov_b32 m0, s9
    s_nop 0
    buffer_load_dwordx4 v196, s[12:15], s55 offen lds
    s_add_u32 s55, s55, 64
    ds_read_b64_tr_b16 v[20:21], v183 offset:28672
    ds_read_b64_tr_b16 v[22:23], v183 offset:29696
    s_waitcnt lgkmcnt(11)
    v_mfma_f32_32x32x16_bf16 v[64:79], v[24:27], v[208:211], v[64:79]
    buffer_load_dwordx4 v196, s[12:15], s56 offen offset:1024 lds
    s_add_u32 s56, s56, 64
    ds_read_b128 v[200:203], v192
    ds_read_b64_tr_b16 v[24:25], v184
    ds_read_b64_tr_b16 v[26:27], v184 offset:1024
    s_waitcnt lgkmcnt(12)
    v_mfma_f32_32x32x16_bf16 v[80:95], v[28:31], v[208:211], v[80:95]
    ds_read_b64_tr_b16 v[28:29], v185
    ds_read_b64_tr_b16 v[30:31], v185 offset:1024
    s_waitcnt lgkmcnt(11)
    v_mfma_f32_32x32x16_bf16 v[32:47], v[216:219], v[212:215], v[32:47]
    ds_read_b64_tr_b16 v[216:217], v186
    ds_read_b64_tr_b16 v[218:219], v186 offset:1024
    s_waitcnt lgkmcnt(11)
    v_mfma_f32_32x32x16_bf16 v[48:63], v[220:223], v[212:215], v[48:63]
    ds_read_b64_tr_b16 v[220:221], v187
    ds_read_b64_tr_b16 v[222:223], v187 offset:1024
    s_waitcnt lgkmcnt(11)
    v_mfma_f32_32x32x16_bf16 v[64:79], v[16:19], v[212:215], v[64:79]
    ds_read_b128 v[204:207], v193
    ds_read_b64_tr_b16 v[16:17], v184 offset:4096
    ds_read_b64_tr_b16 v[18:19], v184 offset:5120
    s_waitcnt lgkmcnt(12)
    v_mfma_f32_32x32x16_bf16 v[80:95], v[20:23], v[212:215], v[80:95]
    s_waitcnt vmcnt(9)
    s_barrier
    ds_read_b64_tr_b16 v[20:21], v185 offset:4096
    ds_read_b64_tr_b16 v[22:23], v185 offset:5120
    s_waitcnt lgkmcnt(11)
    v_mfma_f32_32x32x16_bf16 v[32:47], v[24:27], v[200:203], v[32:47]
    s_add_u32 s9, s61, 73728
    s_mov_b32 m0, s9
    s_nop 0
    buffer_load_dwordx4 v3, s[16:19], s54 offen lds
    s_add_u32 s54, s54, 262144
    ds_read_b64_tr_b16 v[24:25], v186 offset:4096
    ds_read_b64_tr_b16 v[26:27], v186 offset:5120
    s_waitcnt lgkmcnt(11)
    v_mfma_f32_32x32x16_bf16 v[48:63], v[28:31], v[200:203], v[48:63]
    s_add_u32 s9, s60, 81920
    s_mov_b32 m0, s9
    s_nop 0
    buffer_load_dwordx4 v196, s[12:15], s55 offen lds
    s_add_u32 s55, s55, 64
    ds_read_b64_tr_b16 v[28:29], v187 offset:4096
    ds_read_b64_tr_b16 v[30:31], v187 offset:5120
    s_waitcnt lgkmcnt(11)
    v_mfma_f32_32x32x16_bf16 v[64:79], v[216:219], v[200:203], v[64:79]
    buffer_load_dwordx4 v196, s[12:15], s56 offen offset:1024 lds
    s_add_u32 s56, s56, 64
    ds_read_b128 v[208:211], v192 offset:24576
    ds_read_b64_tr_b16 v[216:217], v184 offset:24576
    ds_read_b64_tr_b16 v[218:219], v184 offset:25600
    s_waitcnt lgkmcnt(12)
    v_mfma_f32_32x32x16_bf16 v[80:95], v[220:223], v[200:203], v[80:95]
    ds_read_b64_tr_b16 v[220:221], v185 offset:24576
    ds_read_b64_tr_b16 v[222:223], v185 offset:25600
    s_waitcnt lgkmcnt(11)
    v_mfma_f32_32x32x16_bf16 v[32:47], v[16:19], v[204:207], v[32:47]
    ds_read_b64_tr_b16 v[16:17], v186 offset:24576
    ds_read_b64_tr_b16 v[18:19], v186 offset:25600
    s_waitcnt lgkmcnt(11)
    v_mfma_f32_32x32x16_bf16 v[48:63], v[20:23], v[204:207], v[48:63]
    ds_read_b64_tr_b16 v[20:21], v187 offset:24576
    ds_read_b64_tr_b16 v[22:23], v187 offset:25600
    s_waitcnt lgkmcnt(11)
    v_mfma_f32_32x32x16_bf16 v[64:79], v[24:27], v[204:207], v[64:79]
    ds_read_b128 v[212:215], v193 offset:24576
    ds_read_b64_tr_b16 v[24:25], v184 offset:28672
    ds_read_b64_tr_b16 v[26:27], v184 offset:29696
    s_waitcnt lgkmcnt(12)
    v_mfma_f32_32x32x16_bf16 v[80:95], v[28:31], v[204:207], v[80:95]
    s_waitcnt vmcnt(9)
    s_barrier
    ds_read_b64_tr_b16 v[28:29], v185 offset:28672
    ds_read_b64_tr_b16 v[30:31], v185 offset:29696
    s_waitcnt lgkmcnt(11)
    v_mfma_f32_32x32x16_bf16 v[32:47], v[216:219], v[208:211], v[32:47]
    s_add_u32 s9, s61, 98304
    s_mov_b32 m0, s9
    s_nop 0
    buffer_load_dwordx4 v3, s[16:19], s54 offen lds
    s_add_u32 s54, s54, 262144
    ds_read_b64_tr_b16 v[216:217], v186 offset:28672
    ds_read_b64_tr_b16 v[218:219], v186 offset:29696
    s_waitcnt lgkmcnt(11)
    v_mfma_f32_32x32x16_bf16 v[48:63], v[220:223], v[208:211], v[48:63]
    s_add_u32 s9, s60, 106496
    s_mov_b32 m0, s9
    s_nop 0
    buffer_load_dwordx4 v196, s[12:15], s55 offen lds
    s_add_u32 s55, s55, 64
    ds_read_b64_tr_b16 v[220:221], v187 offset:28672
    ds_read_b64_tr_b16 v[222:223], v187 offset:29696
    s_waitcnt lgkmcnt(11)
    v_mfma_f32_32x32x16_bf16 v[64:79], v[16:19], v[208:211], v[64:79]
    buffer_load_dwordx4 v196, s[12:15], s56 offen offset:1024 lds
    s_add_u32 s56, s56, 64
    ds_read_b128 v[200:203], v188
    ds_read_b64_tr_b16 v[16:17], v176
    ds_read_b64_tr_b16 v[18:19], v176 offset:1024
    s_waitcnt lgkmcnt(12)
    v_mfma_f32_32x32x16_bf16 v[80:95], v[20:23], v[208:211], v[80:95]
    ds_read_b64_tr_b16 v[20:21], v177
    ds_read_b64_tr_b16 v[22:23], v177 offset:1024
    s_waitcnt lgkmcnt(11)
    v_mfma_f32_32x32x16_bf16 v[32:47], v[24:27], v[212:215], v[32:47]
    ds_read_b64_tr_b16 v[24:25], v178
    ds_read_b64_tr_b16 v[26:27], v178 offset:1024
    s_waitcnt lgkmcnt(11)
    v_mfma_f32_32x32x16_bf16 v[48:63], v[28:31], v[212:215], v[48:63]
    ds_read_b64_tr_b16 v[28:29], v179
    ds_read_b64_tr_b16 v[30:31], v179 offset:1024
    s_waitcnt lgkmcnt(11)
    v_mfma_f32_32x32x16_bf16 v[64:79], v[216:219], v[212:215], v[64:79]
    ds_read_b128 v[204:207], v189
    ds_read_b64_tr_b16 v[216:217], v176 offset:4096
    ds_read_b64_tr_b16 v[218:219], v176 offset:5120
    s_waitcnt lgkmcnt(12)
    v_mfma_f32_32x32x16_bf16 v[80:95], v[220:223], v[212:215], v[80:95]
    s_waitcnt vmcnt(9)
    s_barrier
    ds_read_b64_tr_b16 v[220:221], v177 offset:4096
    ds_read_b64_tr_b16 v[222:223], v177 offset:5120
    s_waitcnt lgkmcnt(11)
    v_mfma_f32_32x32x16_bf16 v[32:47], v[16:19], v[200:203], v[32:47]
    s_add_u32 s9, s61, 122880
    s_mov_b32 m0, s9
    s_nop 0
    buffer_load_dwordx4 v3, s[16:19], s54 offen lds
    s_add_u32 s54, s54, 262144
    ds_read_b64_tr_b16 v[16:17], v178 offset:4096
    ds_read_b64_tr_b16 v[18:19], v178 offset:5120
    s_waitcnt lgkmcnt(11)
    v_mfma_f32_32x32x16_bf16 v[48:63], v[20:23], v[200:203], v[48:63]
    s_add_u32 s9, s60, 131072
    s_mov_b32 m0, s9
    s_nop 0
    buffer_load_dwordx4 v196, s[12:15], s55 offen lds
    s_add_u32 s55, s55, 64
    ds_read_b64_tr_b16 v[20:21], v179 offset:4096
    ds_read_b64_tr_b16 v[22:23], v179 offset:5120
    s_waitcnt lgkmcnt(11)
    v_mfma_f32_32x32x16_bf16 v[64:79], v[24:27], v[200:203], v[64:79]
    buffer_load_dwordx4 v196, s[12:15], s56 offen offset:1024 lds
    s_add_u32 s56, s56, 64
    ds_read_b128 v[208:211], v188 offset:24576
    ds_read_b64_tr_b16 v[24:25], v176 offset:24576
    ds_read_b64_tr_b16 v[26:27], v176 offset:25600
    s_waitcnt lgkmcnt(12)
    v_mfma_f32_32x32x16_bf16 v[80:95], v[28:31], v[200:203], v[80:95]
    ds_read_b64_tr_b16 v[28:29], v177 offset:24576
    ds_read_b64_tr_b16 v[30:31], v177 offset:25600
    s_waitcnt lgkmcnt(11)
    v_mfma_f32_32x32x16_bf16 v[32:47], v[216:219], v[204:207], v[32:47]
    ds_read_b64_tr_b16 v[216:217], v178 offset:24576
    ds_read_b64_tr_b16 v[218:219], v178 offset:25600
    s_waitcnt lgkmcnt(11)
    v_mfma_f32_32x32x16_bf16 v[48:63], v[220:223], v[204:207], v[48:63]
    ds_read_b64_tr_b16 v[220:221], v179 offset:24576
    ds_read_b64_tr_b16 v[222:223], v179 offset:25600
    s_waitcnt lgkmcnt(11)
    v_mfma_f32_32x32x16_bf16 v[64:79], v[16:19], v[204:207], v[64:79]
    ds_read_b128 v[212:215], v189 offset:24576
    ds_read_b64_tr_b16 v[16:17], v176 offset:28672
    ds_read_b64_tr_b16 v[18:19], v176 offset:29696
    s_waitcnt lgkmcnt(12)
    v_mfma_f32_32x32x16_bf16 v[80:95], v[20:23], v[204:207], v[80:95]
    s_waitcnt vmcnt(9)
    s_barrier
    ds_read_b64_tr_b16 v[20:21], v177 offset:28672
    ds_read_b64_tr_b16 v[22:23], v177 offset:29696
    s_waitcnt lgkmcnt(11)
    v_mfma_f32_32x32x16_bf16 v[32:47], v[24:27], v[208:211], v[32:47]
    s_add_u32 s9, s61, 0
    s_mov_b32 m0, s9
    s_nop 0
    buffer_load_dwordx4 v3, s[16:19], s54 offen lds
    s_add_u32 s54, s54, 262144
    ds_read_b64_tr_b16 v[24:25], v178 offset:28672
    ds_read_b64_tr_b16 v[26:27], v178 offset:29696
    s_waitcnt lgkmcnt(11)
    v_mfma_f32_32x32x16_bf16 v[48:63], v[28:31], v[208:211], v[48:63]
    s_add_u32 s9, s60, 8192
    s_mov_b32 m0, s9
    s_nop 0
    buffer_load_dwordx4 v196, s[12:15], s55 offen lds
    s_add_u32 s55, s55, 64
    ds_read_b64_tr_b16 v[28:29], v179 offset:28672
    ds_read_b64_tr_b16 v[30:31], v179 offset:29696
    s_waitcnt lgkmcnt(11)
    v_mfma_f32_32x32x16_bf16 v[64:79], v[216:219], v[208:211], v[64:79]
    buffer_load_dwordx4 v196, s[12:15], s56 offen offset:1024 lds
    s_add_u32 s56, s56, 64
    ds_read_b128 v[200:203], v190
    ds_read_b64_tr_b16 v[216:217], v180
    ds_read_b64_tr_b16 v[218:219], v180 offset:1024
    s_waitcnt lgkmcnt(12)
    v_mfma_f32_32x32x16_bf16 v[80:95], v[220:223], v[208:211], v[80:95]
    ds_read_b64_tr_b16 v[220:221], v181
    ds_read_b64_tr_b16 v[222:223], v181 offset:1024
    s_waitcnt lgkmcnt(11)
    v_mfma_f32_32x32x16_bf16 v[32:47], v[16:19], v[212:215], v[32:47]
    ds_read_b64_tr_b16 v[16:17], v182
    ds_read_b64_tr_b16 v[18:19], v182 offset:1024
    s_waitcnt lgkmcnt(11)
    v_mfma_f32_32x32x16_bf16 v[48:63], v[20:23], v[212:215], v[48:63]
    ds_read_b64_tr_b16 v[20:21], v183
    ds_read_b64_tr_b16 v[22:23], v183 offset:1024
    s_waitcnt lgkmcnt(11)
    v_mfma_f32_32x32x16_bf16 v[64:79], v[24:27], v[212:215], v[64:79]
    ds_read_b128 v[204:207], v191
    ds_read_b64_tr_b16 v[24:25], v180 offset:4096
    ds_read_b64_tr_b16 v[26:27], v180 offset:5120
    s_waitcnt lgkmcnt(12)
    v_mfma_f32_32x32x16_bf16 v[80:95], v[28:31], v[212:215], v[80:95]
    s_waitcnt vmcnt(9)
    s_barrier
    ds_read_b64_tr_b16 v[28:29], v181 offset:4096
    ds_read_b64_tr_b16 v[30:31], v181 offset:5120
    s_waitcnt lgkmcnt(11)
    v_mfma_f32_32x32x16_bf16 v[32:47], v[216:219], v[200:203], v[32:47]
    s_add_u32 s9, s61, 24576
    s_mov_b32 m0, s9
    s_nop 0
    buffer_load_dwordx4 v3, s[16:19], s54 offen lds
    s_add_u32 s54, s54, 262144
    ds_read_b64_tr_b16 v[216:217], v182 offset:4096
    ds_read_b64_tr_b16 v[218:219], v182 offset:5120
    s_waitcnt lgkmcnt(11)
    v_mfma_f32_32x32x16_bf16 v[48:63], v[220:223], v[200:203], v[48:63]
    s_add_u32 s9, s60, 32768
    s_mov_b32 m0, s9
    s_nop 0
    buffer_load_dwordx4 v196, s[12:15], s55 offen lds
    s_add_u32 s55, s55, 64
    ds_read_b64_tr_b16 v[220:221], v183 offset:4096
    ds_read_b64_tr_b16 v[222:223], v183 offset:5120
    s_waitcnt lgkmcnt(11)
    v_mfma_f32_32x32x16_bf16 v[64:79], v[16:19], v[200:203], v[64:79]
    buffer_load_dwordx4 v196, s[12:15], s56 offen offset:1024 lds
    s_add_u32 s56, s56, 64
    ds_read_b128 v[208:211], v190 offset:24576
    ds_read_b64_tr_b16 v[16:17], v180 offset:24576
    ds_read_b64_tr_b16 v[18:19], v180 offset:25600
    s_waitcnt lgkmcnt(12)
    v_mfma_f32_32x32x16_bf16 v[80:95], v[20:23], v[200:203], v[80:95]
    ds_read_b64_tr_b16 v[20:21], v181 offset:24576
    ds_read_b64_tr_b16 v[22:23], v181 offset:25600
    s_waitcnt lgkmcnt(11)
    v_mfma_f32_32x32x16_bf16 v[32:47], v[24:27], v[204:207], v[32:47]
    ds_read_b64_tr_b16 v[24:25], v182 offset:24576
    ds_read_b64_tr_b16 v[26:27], v182 offset:25600
    s_waitcnt lgkmcnt(11)
    v_mfma_f32_32x32x16_bf16 v[48:63], v[28:31], v[204:207], v[48:63]
    ds_read_b64_tr_b16 v[28:29], v183 offset:24576
    ds_read_b64_tr_b16 v[30:31], v183 offset:25600
    s_waitcnt lgkmcnt(11)
    v_mfma_f32_32x32x16_bf16 v[64:79], v[216:219], v[204:207], v[64:79]
    ds_read_b128 v[212:215], v191 offset:24576
    ds_read_b64_tr_b16 v[216:217], v180 offset:28672
    ds_read_b64_tr_b16 v[218:219], v180 offset:29696
    s_waitcnt lgkmcnt(12)
    v_mfma_f32_32x32x16_bf16 v[80:95], v[220:223], v[204:207], v[80:95]
    s_waitcnt vmcnt(9)
    s_barrier
    ds_read_b64_tr_b16 v[220:221], v181 offset:28672
    ds_read_b64_tr_b16 v[222:223], v181 offset:29696
    s_waitcnt lgkmcnt(11)
    v_mfma_f32_32x32x16_bf16 v[32:47], v[16:19], v[208:211], v[32:47]
    s_add_u32 s9, s61, 49152
    s_mov_b32 m0, s9
    s_nop 0
    buffer_load_dwordx4 v3, s[16:19], s54 offen lds
    s_add_u32 s54, s54, 262144
    ds_read_b64_tr_b16 v[16:17], v182 offset:28672
    ds_read_b64_tr_b16 v[18:19], v182 offset:29696
    s_waitcnt lgkmcnt(11)
    v_mfma_f32_32x32x16_bf16 v[48:63], v[20:23], v[208:211], v[48:63]
    s_add_u32 s9, s60, 57344
    s_mov_b32 m0, s9
    s_nop 0
    buffer_load_dwordx4 v196, s[12:15], s55 offen lds
    s_add_u32 s55, s55, 64
    ds_read_b64_tr_b16 v[20:21], v183 offset:28672
    ds_read_b64_tr_b16 v[22:23], v183 offset:29696
    s_waitcnt lgkmcnt(11)
    v_mfma_f32_32x32x16_bf16 v[64:79], v[24:27], v[208:211], v[64:79]
    buffer_load_dwordx4 v196, s[12:15], s56 offen offset:1024 lds
    s_add_u32 s56, s56, 64
    ds_read_b128 v[200:203], v192
    ds_read_b64_tr_b16 v[24:25], v184
    ds_read_b64_tr_b16 v[26:27], v184 offset:1024
    s_waitcnt lgkmcnt(12)
    v_mfma_f32_32x32x16_bf16 v[80:95], v[28:31], v[208:211], v[80:95]
    ds_read_b64_tr_b16 v[28:29], v185
    ds_read_b64_tr_b16 v[30:31], v185 offset:1024
    s_waitcnt lgkmcnt(11)
    v_mfma_f32_32x32x16_bf16 v[32:47], v[216:219], v[212:215], v[32:47]
    ds_read_b64_tr_b16 v[216:217], v186
    ds_read_b64_tr_b16 v[218:219], v186 offset:1024
    s_waitcnt lgkmcnt(11)
    v_mfma_f32_32x32x16_bf16 v[48:63], v[220:223], v[212:215], v[48:63]
    ds_read_b64_tr_b16 v[220:221], v187
    ds_read_b64_tr_b16 v[222:223], v187 offset:1024
    s_waitcnt lgkmcnt(11)
    v_mfma_f32_32x32x16_bf16 v[64:79], v[16:19], v[212:215], v[64:79]
    ds_read_b128 v[204:207], v193
    ds_read_b64_tr_b16 v[16:17], v184 offset:4096
    ds_read_b64_tr_b16 v[18:19], v184 offset:5120
    s_waitcnt lgkmcnt(12)
    v_mfma_f32_32x32x16_bf16 v[80:95], v[20:23], v[212:215], v[80:95]
    s_waitcnt vmcnt(9)
    s_barrier
    ds_read_b64_tr_b16 v[20:21], v185 offset:4096
    ds_read_b64_tr_b16 v[22:23], v185 offset:5120
    s_waitcnt lgkmcnt(11)
    v_mfma_f32_32x32x16_bf16 v[32:47], v[24:27], v[200:203], v[32:47]
    s_add_u32 s9, s61, 73728
    s_mov_b32 m0, s9
    s_nop 0
    buffer_load_dwordx4 v3, s[16:19], s54 offen lds
    s_add_u32 s54, s54, 262144
    ds_read_b64_tr_b16 v[24:25], v186 offset:4096
    ds_read_b64_tr_b16 v[26:27], v186 offset:5120
    s_waitcnt lgkmcnt(11)
    v_mfma_f32_32x32x16_bf16 v[48:63], v[28:31], v[200:203], v[48:63]
    s_add_u32 s9, s60, 81920
    s_mov_b32 m0, s9
    s_nop 0
    buffer_load_dwordx4 v196, s[12:15], s55 offen lds
    s_add_u32 s55, s55, 64
    ds_read_b64_tr_b16 v[28:29], v187 offset:4096
    ds_read_b64_tr_b16 v[30:31], v187 offset:5120
    s_waitcnt lgkmcnt(11)
    v_mfma_f32_32x32x16_bf16 v[64:79], v[216:219], v[200:203], v[64:79]
    buffer_load_dwordx4 v196, s[12:15], s56 offen offset:1024 lds
    s_add_u32 s56, s56, 64
    ds_read_b128 v[208:211], v192 offset:24576
    ds_read_b64_tr_b16 v[216:217], v184 offset:24576
    ds_read_b64_tr_b16 v[218:219], v184 offset:25600
    s_waitcnt lgkmcnt(12)
    v_mfma_f32_32x32x16_bf16 v[80:95], v[220:223], v[200:203], v[80:95]
    ds_read_b64_tr_b16 v[220:221], v185 offset:24576
    ds_read_b64_tr_b16 v[222:223], v185 offset:25600
    s_waitcnt lgkmcnt(11)
    v_mfma_f32_32x32x16_bf16 v[32:47], v[16:19], v[204:207], v[32:47]
    ds_read_b64_tr_b16 v[16:17], v186 offset:24576
    ds_read_b64_tr_b16 v[18:19], v186 offset:25600
    s_waitcnt lgkmcnt(11)
    v_mfma_f32_32x32x16_bf16 v[48:63], v[20:23], v[204:207], v[48:63]
    ds_read_b64_tr_b16 v[20:21], v187 offset:24576
    ds_read_b64_tr_b16 v[22:23], v187 offset:25600
    s_waitcnt lgkmcnt(11)
    v_mfma_f32_32x32x16_bf16 v[64:79], v[24:27], v[204:207], v[64:79]
    ds_read_b128 v[212:215], v193 offset:24576
    ds_read_b64_tr_b16 v[24:25], v184 offset:28672
    ds_read_b64_tr_b16 v[26:27], v184 offset:29696
    s_waitcnt lgkmcnt(12)
    v_mfma_f32_32x32x16_bf16 v[80:95], v[28:31], v[204:207], v[80:95]
    s_waitcnt vmcnt(9)
    s_barrier
    ds_read_b64_tr_b16 v[28:29], v185 offset:28672
    ds_read_b64_tr_b16 v[30:31], v185 offset:29696
    s_waitcnt lgkmcnt(11)
    v_mfma_f32_32x32x16_bf16 v[32:47], v[216:219], v[208:211], v[32:47]
    s_add_u32 s9, s61, 98304
    s_mov_b32 m0, s9
    s_nop 0
    buffer_load_dwordx4 v3, s[16:19], s54 offen lds
    s_add_u32 s54, s54, 262144
    ds_read_b64_tr_b16 v[216:217], v186 offset:28672
    ds_read_b64_tr_b16 v[218:219], v186 offset:29696
    s_waitcnt lgkmcnt(11)
    v_mfma_f32_32x32x16_bf16 v[48:63], v[220:223], v[208:211], v[48:63]
    s_add_u32 s9, s60, 106496
    s_mov_b32 m0, s9
    s_nop 0
    buffer_load_dwordx4 v196, s[12:15], s55 offen lds
    s_add_u32 s55, s55, 64
    ds_read_b64_tr_b16 v[220:221], v187 offset:28672
    ds_read_b64_tr_b16 v[222:223], v187 offset:29696
    s_waitcnt lgkmcnt(11)
    v_mfma_f32_32x32x16_bf16 v[64:79], v[16:19], v[208:211], v[64:79]
    buffer_load_dwordx4 v196, s[12:15], s56 offen offset:1024 lds
    s_add_u32 s56, s56, 64
    ds_read_b128 v[200:203], v188
    ds_read_b64_tr_b16 v[16:17], v176
    ds_read_b64_tr_b16 v[18:19], v176 offset:1024
    s_waitcnt lgkmcnt(12)
    v_mfma_f32_32x32x16_bf16 v[80:95], v[20:23], v[208:211], v[80:95]
    ds_read_b64_tr_b16 v[20:21], v177
    ds_read_b64_tr_b16 v[22:23], v177 offset:1024
    s_waitcnt lgkmcnt(11)
    v_mfma_f32_32x32x16_bf16 v[32:47], v[24:27], v[212:215], v[32:47]
    ds_read_b64_tr_b16 v[24:25], v178
    ds_read_b64_tr_b16 v[26:27], v178 offset:1024
    s_waitcnt lgkmcnt(11)
    v_mfma_f32_32x32x16_bf16 v[48:63], v[28:31], v[212:215], v[48:63]
    ds_read_b64_tr_b16 v[28:29], v179
    ds_read_b64_tr_b16 v[30:31], v179 offset:1024
    s_waitcnt lgkmcnt(11)
    v_mfma_f32_32x32x16_bf16 v[64:79], v[216:219], v[212:215], v[64:79]
    ds_read_b128 v[204:207], v189
    ds_read_b64_tr_b16 v[216:217], v176 offset:4096
    ds_read_b64_tr_b16 v[218:219], v176 offset:5120
    s_waitcnt lgkmcnt(12)
    v_mfma_f32_32x32x16_bf16 v[80:95], v[220:223], v[212:215], v[80:95]
    s_waitcnt vmcnt(9)
    s_barrier
    ds_read_b64_tr_b16 v[220:221], v177 offset:4096
    ds_read_b64_tr_b16 v[222:223], v177 offset:5120
    s_waitcnt lgkmcnt(11)
    v_mfma_f32_32x32x16_bf16 v[32:47], v[16:19], v[200:203], v[32:47]
    s_add_u32 s9, s61, 122880
    s_mov_b32 m0, s9
    s_nop 0
    buffer_load_dwordx4 v3, s[16:19], s54 offen lds
    s_add_u32 s54, s54, 262144
    ds_read_b64_tr_b16 v[16:17], v178 offset:4096
    ds_read_b64_tr_b16 v[18:19], v178 offset:5120
    s_waitcnt lgkmcnt(11)
    v_mfma_f32_32x32x16_bf16 v[48:63], v[20:23], v[200:203], v[48:63]
    s_add_u32 s9, s60, 131072
    s_mov_b32 m0, s9
    s_nop 0
    buffer_load_dwordx4 v196, s[12:15], s55 offen lds
    s_add_u32 s55, s55, 64
    ds_read_b64_tr_b16 v[20:21], v179 offset:4096
    ds_read_b64_tr_b16 v[22:23], v179 offset:5120
    s_waitcnt lgkmcnt(11)
    v_mfma_f32_32x32x16_bf16 v[64:79], v[24:27], v[200:203], v[64:79]
    buffer_load_dwordx4 v196, s[12:15], s56 offen offset:1024 lds
    s_add_u32 s56, s56, 64
    ds_read_b128 v[208:211], v188 offset:24576
    ds_read_b64_tr_b16 v[24:25], v176 offset:24576
    ds_read_b64_tr_b16 v[26:27], v176 offset:25600
    s_waitcnt lgkmcnt(12)
    v_mfma_f32_32x32x16_bf16 v[80:95], v[28:31], v[200:203], v[80:95]
    ds_read_b64_tr_b16 v[28:29], v177 offset:24576
    ds_read_b64_tr_b16 v[30:31], v177 offset:25600
    s_waitcnt lgkmcnt(11)
    v_mfma_f32_32x32x16_bf16 v[32:47], v[216:219], v[204:207], v[32:47]
    ds_read_b64_tr_b16 v[216:217], v178 offset:24576
    ds_read_b64_tr_b16 v[218:219], v178 offset:25600
    s_waitcnt lgkmcnt(11)
    v_mfma_f32_32x32x16_bf16 v[48:63], v[220:223], v[204:207], v[48:63]
    ds_read_b64_tr_b16 v[220:221], v179 offset:24576
    ds_read_b64_tr_b16 v[222:223], v179 offset:25600
    s_waitcnt lgkmcnt(11)
    v_mfma_f32_32x32x16_bf16 v[64:79], v[16:19], v[204:207], v[64:79]
    ds_read_b128 v[212:215], v189 offset:24576
    ds_read_b64_tr_b16 v[16:17], v176 offset:28672
    ds_read_b64_tr_b16 v[18:19], v176 offset:29696
    s_waitcnt lgkmcnt(12)
    v_mfma_f32_32x32x16_bf16 v[80:95], v[20:23], v[204:207], v[80:95]
    s_waitcnt vmcnt(9)
    s_barrier
    ds_read_b64_tr_b16 v[20:21], v177 offset:28672
    ds_read_b64_tr_b16 v[22:23], v177 offset:29696
    s_waitcnt lgkmcnt(11)
    v_mfma_f32_32x32x16_bf16 v[32:47], v[24:27], v[208:211], v[32:47]
    s_add_u32 s9, s61, 0
    s_mov_b32 m0, s9
    s_nop 0
    buffer_load_dwordx4 v3, s[16:19], s54 offen lds
    s_add_u32 s54, s54, 262144
    ds_read_b64_tr_b16 v[24:25], v178 offset:28672
    ds_read_b64_tr_b16 v[26:27], v178 offset:29696
    s_waitcnt lgkmcnt(11)
    v_mfma_f32_32x32x16_bf16 v[48:63], v[28:31], v[208:211], v[48:63]
    s_add_u32 s9, s60, 8192
    s_mov_b32 m0, s9
    s_nop 0
    buffer_load_dwordx4 v196, s[12:15], s55 offen lds
    s_add_u32 s55, s55, 64
    ds_read_b64_tr_b16 v[28:29], v179 offset:28672
    ds_read_b64_tr_b16 v[30:31], v179 offset:29696
    s_waitcnt lgkmcnt(11)
    v_mfma_f32_32x32x16_bf16 v[64:79], v[216:219], v[208:211], v[64:79]
    buffer_load_dwordx4 v196, s[12:15], s56 offen offset:1024 lds
    s_add_u32 s56, s56, 64
    ds_read_b128 v[200:203], v190
    ds_read_b64_tr_b16 v[216:217], v180
    ds_read_b64_tr_b16 v[218:219], v180 offset:1024
    s_waitcnt lgkmcnt(12)
    v_mfma_f32_32x32x16_bf16 v[80:95], v[220:223], v[208:211], v[80:95]
    ds_read_b64_tr_b16 v[220:221], v181
    ds_read_b64_tr_b16 v[222:223], v181 offset:1024
    s_waitcnt lgkmcnt(11)
    v_mfma_f32_32x32x16_bf16 v[32:47], v[16:19], v[212:215], v[32:47]
    ds_read_b64_tr_b16 v[16:17], v182
    ds_read_b64_tr_b16 v[18:19], v182 offset:1024
    s_waitcnt lgkmcnt(11)
    v_mfma_f32_32x32x16_bf16 v[48:63], v[20:23], v[212:215], v[48:63]
    ds_read_b64_tr_b16 v[20:21], v183
    ds_read_b64_tr_b16 v[22:23], v183 offset:1024
    s_waitcnt lgkmcnt(11)
    v_mfma_f32_32x32x16_bf16 v[64:79], v[24:27], v[212:215], v[64:79]
    ds_read_b128 v[204:207], v191
    ds_read_b64_tr_b16 v[24:25], v180 offset:4096
    ds_read_b64_tr_b16 v[26:27], v180 offset:5120
    s_waitcnt lgkmcnt(12)
    v_mfma_f32_32x32x16_bf16 v[80:95], v[28:31], v[212:215], v[80:95]
    s_waitcnt vmcnt(9)
    s_barrier
    ds_read_b64_tr_b16 v[28:29], v181 offset:4096
    ds_read_b64_tr_b16 v[30:31], v181 offset:5120
    s_waitcnt lgkmcnt(11)
    v_mfma_f32_32x32x16_bf16 v[32:47], v[216:219], v[200:203], v[32:47]
    s_add_u32 s9, s61, 24576
    s_mov_b32 m0, s9
    s_nop 0
    buffer_load_dwordx4 v3, s[16:19], s54 offen lds
    s_add_u32 s54, s54, 262144
    ds_read_b64_tr_b16 v[216:217], v182 offset:4096
    ds_read_b64_tr_b16 v[218:219], v182 offset:5120
    s_waitcnt lgkmcnt(11)
    v_mfma_f32_32x32x16_bf16 v[48:63], v[220:223], v[200:203], v[48:63]
    s_add_u32 s9, s60, 32768
    s_mov_b32 m0, s9
    s_nop 0
    buffer_load_dwordx4 v196, s[12:15], s55 offen lds
    s_add_u32 s55, s55, 64
    ds_read_b64_tr_b16 v[220:221], v183 offset:4096
    ds_read_b64_tr_b16 v[222:223], v183 offset:5120
    s_waitcnt lgkmcnt(11)
    v_mfma_f32_32x32x16_bf16 v[64:79], v[16:19], v[200:203], v[64:79]
    buffer_load_dwordx4 v196, s[12:15], s56 offen offset:1024 lds
    s_add_u32 s56, s56, 64
    ds_read_b128 v[208:211], v190 offset:24576
    ds_read_b64_tr_b16 v[16:17], v180 offset:24576
    ds_read_b64_tr_b16 v[18:19], v180 offset:25600
    s_waitcnt lgkmcnt(12)
    v_mfma_f32_32x32x16_bf16 v[80:95], v[20:23], v[200:203], v[80:95]
    ds_read_b64_tr_b16 v[20:21], v181 offset:24576
    ds_read_b64_tr_b16 v[22:23], v181 offset:25600
    s_waitcnt lgkmcnt(11)
    v_mfma_f32_32x32x16_bf16 v[32:47], v[24:27], v[204:207], v[32:47]
    ds_read_b64_tr_b16 v[24:25], v182 offset:24576
    ds_read_b64_tr_b16 v[26:27], v182 offset:25600
    s_waitcnt lgkmcnt(11)
    v_mfma_f32_32x32x16_bf16 v[48:63], v[28:31], v[204:207], v[48:63]
    ds_read_b64_tr_b16 v[28:29], v183 offset:24576
    ds_read_b64_tr_b16 v[30:31], v183 offset:25600
    s_waitcnt lgkmcnt(11)
    v_mfma_f32_32x32x16_bf16 v[64:79], v[216:219], v[204:207], v[64:79]
    ds_read_b128 v[212:215], v191 offset:24576
    ds_read_b64_tr_b16 v[216:217], v180 offset:28672
    ds_read_b64_tr_b16 v[218:219], v180 offset:29696
    s_waitcnt lgkmcnt(12)
    v_mfma_f32_32x32x16_bf16 v[80:95], v[220:223], v[204:207], v[80:95]
    s_waitcnt vmcnt(9)
    s_barrier
    ds_read_b64_tr_b16 v[220:221], v181 offset:28672
    ds_read_b64_tr_b16 v[222:223], v181 offset:29696
    s_waitcnt lgkmcnt(11)
    v_mfma_f32_32x32x16_bf16 v[32:47], v[16:19], v[208:211], v[32:47]
    s_add_u32 s78, s71, 0
    v_add_u32 v198, s78, v197
    ds_read_b64_tr_b16 v[16:17], v182 offset:28672
    ds_read_b64_tr_b16 v[18:19], v182 offset:29696
    s_waitcnt lgkmcnt(11)
    v_mfma_f32_32x32x16_bf16 v[48:63], v[20:23], v[208:211], v[48:63]
    ds_write_b128 v198, v[96:99]
    ds_read_b64_tr_b16 v[20:21], v183 offset:28672
    ds_read_b64_tr_b16 v[22:23], v183 offset:29696
    s_waitcnt lgkmcnt(12)
    v_mfma_f32_32x32x16_bf16 v[64:79], v[24:27], v[208:211], v[64:79]
    ds_write_b128 v198, v[100:103] offset:1024
    ds_read_b128 v[200:203], v192
    ds_read_b64_tr_b16 v[24:25], v184
    ds_read_b64_tr_b16 v[26:27], v184 offset:1024
    s_waitcnt lgkmcnt(14)
    v_mfma_f32_32x32x16_bf16 v[80:95], v[28:31], v[208:211], v[80:95]
    ds_write_b128 v198, v[104:107] offset:2048
    ds_read_b64_tr_b16 v[28:29], v185
    ds_read_b64_tr_b16 v[30:31], v185 offset:1024
    s_waitcnt lgkmcnt(14)
    v_mfma_f32_32x32x16_bf16 v[32:47], v[216:219], v[212:215], v[32:47]
    ds_write_b128 v198, v[108:111] offset:3072
    ds_read_b64_tr_b16 v[216:217], v186
    ds_read_b64_tr_b16 v[218:219], v186 offset:1024
    s_waitcnt lgkmcnt(15)
    v_mfma_f32_32x32x16_bf16 v[48:63], v[220:223], v[212:215], v[48:63]
    ds_read_b64_tr_b16 v[220:221], v187
    ds_read_b64_tr_b16 v[222:223], v187 offset:1024
    s_waitcnt lgkmcnt(15)
    v_mfma_f32_32x32x16_bf16 v[64:79], v[16:19], v[212:215], v[64:79]
    ds_read_b128 v[204:207], v193
    ds_read_b64_tr_b16 v[16:17], v184 offset:4096
    ds_read_b64_tr_b16 v[18:19], v184 offset:5120
    s_waitcnt lgkmcnt(15)
    v_mfma_f32_32x32x16_bf16 v[80:95], v[20:23], v[212:215], v[80:95]
    s_waitcnt vmcnt(6)
    s_barrier
    ds_read_b64_tr_b16 v[20:21], v185 offset:4096
    ds_read_b64_tr_b16 v[22:23], v185 offset:5120
    s_waitcnt lgkmcnt(13)
    v_mfma_f32_32x32x16_bf16 v[32:47], v[24:27], v[200:203], v[32:47]
    s_add_u32 s78, s71, 16384
    s_cmp_ge_u32 s78, 81920
    s_cselect_b32 s10, 81920, 0
    s_sub_u32 s78, s78, s10
    v_add_u32 v198, s78, v197
    ds_read_b64_tr_b16 v[24:25], v186 offset:4096
    ds_read_b64_tr_b16 v[26:27], v186 offset:5120
    s_waitcnt lgkmcnt(12)
    v_mfma_f32_32x32x16_bf16 v[48:63], v[28:31], v[200:203], v[48:63]
    ds_write_b128 v198, v[112:115]
    ds_read_b64_tr_b16 v[28:29], v187 offset:4096
    ds_read_b64_tr_b16 v[30:31], v187 offset:5120
    s_waitcnt lgkmcnt(12)
    v_mfma_f32_32x32x16_bf16 v[64:79], v[216:219], v[200:203], v[64:79]
    ds_write_b128 v198, v[116:119] offset:1024
    ds_read_b128 v[208:211], v192 offset:24576
    ds_read_b64_tr_b16 v[216:217], v184 offset:24576
    ds_read_b64_tr_b16 v[218:219], v184 offset:25600
    s_waitcnt lgkmcnt(14)
    v_mfma_f32_32x32x16_bf16 v[80:95], v[220:223], v[200:203], v[80:95]
    ds_write_b128 v198, v[120:123] offset:2048
    ds_read_b64_tr_b16 v[220:221], v185 offset:24576
    ds_read_b64_tr_b16 v[222:223], v185 offset:25600
    s_waitcnt lgkmcnt(14)
    v_mfma_f32_32x32x16_bf16 v[32:47], v[16:19], v[204:207], v[32:47]
    ds_write_b128 v198, v[124:127] offset:3072
    ds_read_b64_tr_b16 v[16:17], v186 offset:24576
    ds_read_b64_tr_b16 v[18:19], v186 offset:25600
    s_waitcnt lgkmcnt(15)
    v_mfma_f32_32x32x16_bf16 v[48:63], v[20:23], v[204:207], v[48:63]
    ds_read_b64_tr_b16 v[20:21], v187 offset:24576
    ds_read_b64_tr_b16 v[22:23], v187 offset:25600
    s_waitcnt lgkmcnt(15)
    v_mfma_f32_32x32x16_bf16 v[64:79], v[24:27], v[204:207], v[64:79]
    ds_read_b128 v[212:215], v193 offset:24576
    ds_read_b64_tr_b16 v[24:25], v184 offset:28672
    ds_read_b64_tr_b16 v[26:27], v184 offset:29696
    s_waitcnt lgkmcnt(15)
    v_mfma_f32_32x32x16_bf16 v[80:95], v[28:31], v[204:207], v[80:95]
    s_waitcnt vmcnt(3)
    s_barrier
    ds_read_b64_tr_b16 v[28:29], v185 offset:28672
    ds_read_b64_tr_b16 v[30:31], v185 offset:29696
    s_waitcnt lgkmcnt(13)
    v_mfma_f32_32x32x16_bf16 v[32:47], v[216:219], v[208:211], v[32:47]
    ds_read_b64_tr_b16 v[216:217], v186 offset:28672
    ds_read_b64_tr_b16 v[218:219], v186 offset:29696
    s_waitcnt lgkmcnt(12)
    v_mfma_f32_32x32x16_bf16 v[48:63], v[220:223], v[208:211], v[48:63]
    ds_read_b64_tr_b16 v[220:221], v187 offset:28672
    ds_read_b64_tr_b16 v[222:223], v187 offset:29696
    s_waitcnt lgkmcnt(11)
    v_mfma_f32_32x32x16_bf16 v[64:79], v[16:19], v[208:211], v[64:79]
    ds_read_b128 v[200:203], v188
    ds_read_b64_tr_b16 v[16:17], v176
    ds_read_b64_tr_b16 v[18:19], v176 offset:1024
    s_waitcnt lgkmcnt(12)
    v_mfma_f32_32x32x16_bf16 v[80:95], v[20:23], v[208:211], v[80:95]
    ds_read_b64_tr_b16 v[20:21], v177
    ds_read_b64_tr_b16 v[22:23], v177 offset:1024
    s_waitcnt lgkmcnt(11)
    v_mfma_f32_32x32x16_bf16 v[32:47], v[24:27], v[212:215], v[32:47]
    ds_read_b64_tr_b16 v[24:25], v178
    ds_read_b64_tr_b16 v[26:27], v178 offset:1024
    s_waitcnt lgkmcnt(11)
    v_mfma_f32_32x32x16_bf16 v[48:63], v[28:31], v[212:215], v[48:63]
    ds_read_b64_tr_b16 v[28:29], v179
    ds_read_b64_tr_b16 v[30:31], v179 offset:1024
    s_waitcnt lgkmcnt(11)
    v_mfma_f32_32x32x16_bf16 v[64:79], v[216:219], v[212:215], v[64:79]
    ds_read_b128 v[204:207], v189
    ds_read_b64_tr_b16 v[216:217], v176 offset:4096
    ds_read_b64_tr_b16 v[218:219], v176 offset:5120
    s_waitcnt lgkmcnt(12)
    v_mfma_f32_32x32x16_bf16 v[80:95], v[220:223], v[212:215], v[80:95]
    s_waitcnt vmcnt(0)
    s_barrier
    ds_read_b64_tr_b16 v[220:221], v177 offset:4096
    ds_read_b64_tr_b16 v[222:223], v177 offset:5120
    s_waitcnt lgkmcnt(11)
    v_mfma_f32_32x32x16_bf16 v[32:47], v[16:19], v[200:203], v[32:47]
    ds_read_b64_tr_b16 v[16:17], v178 offset:4096
    ds_read_b64_tr_b16 v[18:19], v178 offset:5120
    s_waitcnt lgkmcnt(11)
    v_mfma_f32_32x32x16_bf16 v[48:63], v[20:23], v[200:203], v[48:63]
    ds_read_b64_tr_b16 v[20:21], v179 offset:4096
    ds_read_b64_tr_b16 v[22:23], v179 offset:5120
    s_waitcnt lgkmcnt(11)
    v_mfma_f32_32x32x16_bf16 v[64:79], v[24:27], v[200:203], v[64:79]
    ds_read_b128 v[208:211], v188 offset:24576
    ds_read_b64_tr_b16 v[24:25], v176 offset:24576
    ds_read_b64_tr_b16 v[26:27], v176 offset:25600
    s_waitcnt lgkmcnt(12)
    v_mfma_f32_32x32x16_bf16 v[80:95], v[28:31], v[200:203], v[80:95]
    ds_read_b64_tr_b16 v[28:29], v177 offset:24576
    ds_read_b64_tr_b16 v[30:31], v177 offset:25600
    s_waitcnt lgkmcnt(11)
    v_mfma_f32_32x32x16_bf16 v[32:47], v[216:219], v[204:207], v[32:47]
    ds_read_b64_tr_b16 v[216:217], v178 offset:24576
    ds_read_b64_tr_b16 v[218:219], v178 offset:25600
    s_waitcnt lgkmcnt(11)
    v_mfma_f32_32x32x16_bf16 v[48:63], v[220:223], v[204:207], v[48:63]
    ds_read_b64_tr_b16 v[220:221], v179 offset:24576
    ds_read_b64_tr_b16 v[222:223], v179 offset:25600
    s_waitcnt lgkmcnt(11)
    v_mfma_f32_32x32x16_bf16 v[64:79], v[16:19], v[204:207], v[64:79]
    ds_read_b128 v[212:215], v189 offset:24576
    ds_read_b64_tr_b16 v[16:17], v176 offset:28672
    ds_read_b64_tr_b16 v[18:19], v176 offset:29696
    s_waitcnt lgkmcnt(12)
    v_mfma_f32_32x32x16_bf16 v[80:95], v[20:23], v[204:207], v[80:95]
    s_barrier
    ds_read_b64_tr_b16 v[20:21], v177 offset:28672
    ds_read_b64_tr_b16 v[22:23], v177 offset:29696
    s_waitcnt lgkmcnt(11)
    v_mfma_f32_32x32x16_bf16 v[32:47], v[24:27], v[208:211], v[32:47]
    s_add_u32 s78, s71, 32768
    s_cmp_ge_u32 s78, 81920
    s_cselect_b32 s10, 81920, 0
    s_sub_u32 s78, s78, s10
    v_add_u32 v198, s78, v197
    ds_read_b64_tr_b16 v[24:25], v178 offset:28672
    ds_read_b64_tr_b16 v[26:27], v178 offset:29696
    s_waitcnt lgkmcnt(11)
    v_mfma_f32_32x32x16_bf16 v[48:63], v[28:31], v[208:211], v[48:63]
    ds_write_b128 v198, v[128:131]
    ds_read_b64_tr_b16 v[28:29], v179 offset:28672
    ds_read_b64_tr_b16 v[30:31], v179 offset:29696
    s_waitcnt lgkmcnt(12)
    v_mfma_f32_32x32x16_bf16 v[64:79], v[216:219], v[208:211], v[64:79]
    ds_write_b128 v198, v[132:135] offset:1024
    s_waitcnt lgkmcnt(11)
    v_mfma_f32_32x32x16_bf16 v[80:95], v[220:223], v[208:211], v[80:95]
    ds_write_b128 v198, v[136:139] offset:2048
    s_waitcnt lgkmcnt(9)
    v_mfma_f32_32x32x16_bf16 v[32:47], v[16:19], v[212:215], v[32:47]
    ds_write_b128 v198, v[140:143] offset:3072
    s_waitcnt lgkmcnt(8)
    v_mfma_f32_32x32x16_bf16 v[48:63], v[20:23], v[212:215], v[48:63]
    s_waitcnt lgkmcnt(6)
    v_mfma_f32_32x32x16_bf16 v[64:79], v[24:27], v[212:215], v[64:79]
    s_waitcnt lgkmcnt(3)
    v_mfma_f32_32x32x16_bf16 v[80:95], v[28:31], v[212:215], v[80:95]
    s_barrier
    s_add_u32 s78, s71, 49152
    s_cmp_ge_u32 s78, 81920
    s_cselect_b32 s10, 81920, 0
    s_sub_u32 s78, s78, s10
    s_add_u32 s78, s78, s77
    s_mov_b32 m0, s78
    s_add_u32 s78, s79, 16384
    buffer_load_dwordx4 v2, s[24:27], s78 offen nt lds
    buffer_load_dwordx4 v2, s[24:27], s78 offen offset:1024 nt lds
    buffer_load_dwordx4 v2, s[24:27], s78 offen offset:2048 nt lds
    buffer_load_dwordx4 v2, s[24:27], s78 offen offset:3072 nt lds
    s_add_u32 s78, s71, 65536
    s_cmp_ge_u32 s78, 81920
    s_cselect_b32 s10, 81920, 0
    s_sub_u32 s78, s78, s10
    s_add_u32 s78, s78, s77
    s_mov_b32 m0, s78
    s_add_u32 s78, s79, 32768
    buffer_load_dwordx4 v4, s[20:23], s78 offen nt lds
    buffer_load_dwordx4 v5, s[20:23], s78 offen offset:1024 nt lds
    buffer_load_dwordx4 v6, s[20:23], s78 offen offset:2048 nt lds
    buffer_load_dwordx4 v7, s[20:23], s78 offen offset:3072 nt lds
    v_cvt_pk_bf16_f32 v224, v32, v33
    v_cvt_pk_bf16_f32 v225, v34, v35
    v_cvt_pk_bf16_f32 v226, v36, v37
    v_cvt_pk_bf16_f32 v227, v38, v39
    v_cvt_pk_bf16_f32 v228, v40, v41
    v_cvt_pk_bf16_f32 v229, v42, v43
    v_cvt_pk_bf16_f32 v230, v44, v45
    v_cvt_pk_bf16_f32 v231, v46, v47
    v_cvt_pk_bf16_f32 v232, v48, v49
    v_cvt_pk_bf16_f32 v233, v50, v51
    v_cvt_pk_bf16_f32 v234, v52, v53
    v_cvt_pk_bf16_f32 v235, v54, v55
    v_cvt_pk_bf16_f32 v236, v56, v57
    v_cvt_pk_bf16_f32 v237, v58, v59
    v_cvt_pk_bf16_f32 v238, v60, v61
    v_cvt_pk_bf16_f32 v239, v62, v63
    v_cvt_pk_bf16_f32 v240, v64, v65
    v_cvt_pk_bf16_f32 v241, v66, v67
    v_cvt_pk_bf16_f32 v242, v68, v69
    v_cvt_pk_bf16_f32 v243, v70, v71
    v_cvt_pk_bf16_f32 v244, v72, v73
    v_cvt_pk_bf16_f32 v245, v74, v75
    v_cvt_pk_bf16_f32 v246, v76, v77
    v_cvt_pk_bf16_f32 v247, v78, v79
    v_cvt_pk_bf16_f32 v248, v80, v81
    v_cvt_pk_bf16_f32 v249, v82, v83
    v_cvt_pk_bf16_f32 v250, v84, v85
    v_cvt_pk_bf16_f32 v251, v86, v87
    v_cvt_pk_bf16_f32 v252, v88, v89
    v_cvt_pk_bf16_f32 v253, v90, v91
    v_cvt_pk_bf16_f32 v254, v92, v93
    v_cvt_pk_bf16_f32 v255, v94, v95
L_join:
    s_nop 7
    s_waitcnt lgkmcnt(0)
    s_add_u32 s78, s71, 32768
    s_cmp_ge_u32 s78, 81920
    s_cselect_b32 s10, 81920, 0
    s_sub_u32 s78, s78, s10
    s_add_u32 s78, s78, s70
    v_add_u32 v200, s78, v176
    v_add_u32 v201, s78, v177
    v_add_u32 v202, s78, v178
    v_add_u32 v203, s78, v179
    v_mov_b32 v32, 0
    v_mov_b32 v33, 0
    v_mov_b32 v34, 0
    v_mov_b32 v35, 0
    v_mov_b32 v36, 0
    v_mov_b32 v37, 0
    v_mov_b32 v38, 0
    v_mov_b32 v39, 0
    v_mov_b32 v40, 0
    v_mov_b32 v41, 0
    v_mov_b32 v42, 0
    v_mov_b32 v43, 0
    v_mov_b32 v44, 0
    v_mov_b32 v45, 0
    v_mov_b32 v46, 0
    v_mov_b32 v47, 0
    v_mov_b32 v48, 0
    v_mov_b32 v49, 0
    v_mov_b32 v50, 0
    v_mov_b32 v51, 0
    v_mov_b32 v52, 0
    v_mov_b32 v53, 0
    v_mov_b32 v54, 0
    v_mov_b32 v55, 0
    v_mov_b32 v56, 0
    v_mov_b32 v57, 0
    v_mov_b32 v58, 0
    v_mov_b32 v59, 0
    v_mov_b32 v60, 0
    v_mov_b32 v61, 0
    v_mov_b32 v62, 0
    v_mov_b32 v63, 0
    v_mov_b32 v64, 0
    v_mov_b32 v65, 0
    v_mov_b32 v66, 0
    v_mov_b32 v67, 0
    v_mov_b32 v68, 0
    v_mov_b32 v69, 0
    v_mov_b32 v70, 0
    v_mov_b32 v71, 0
    v_mov_b32 v72, 0
    v_mov_b32 v73, 0
    v_mov_b32 v74, 0
    v_mov_b32 v75, 0
    v_mov_b32 v76, 0
    v_mov_b32 v77, 0
    v_mov_b32 v78, 0
    v_mov_b32 v79, 0
    v_mov_b32 v80, 0
    v_mov_b32 v81, 0
    v_mov_b32 v82, 0
    v_mov_b32 v83, 0
    v_mov_b32 v84, 0
    v_mov_b32 v85, 0
    v_mov_b32 v86, 0
    v_mov_b32 v87, 0
    v_mov_b32 v88, 0
    v_mov_b32 v89, 0
    v_mov_b32 v90, 0
    v_mov_b32 v91, 0
    v_mov_b32 v92, 0
    v_mov_b32 v93, 0
    v_mov_b32 v94, 0
    v_mov_b32 v95, 0
    v_mov_b32 v204, 0xff800000
    v_mov_b32 v205, 0
    v_mov_b32 v212, 0
    s_mov_b32 s75, 0
    s_mov_b32 s62, 0x427af233
    s_barrier
    ds_read_b128 v[16:19], v8
    ds_read_b128 v[20:23], v9
    ds_read_b128 v[24:27], v10
    ds_read_b128 v[28:31], v11
    ds_read_b128 v[160:163], v12
    ds_read_b128 v[164:167], v13
    ds_read_b128 v[168:171], v14
L_loop:
    ds_read_b128 v[172:175], v15
    s_waitcnt lgkmcnt(7)
    v_mfma_f32_32x32x16_bf16 v[96:111], v[16:19], v[224:227], 0
    s_add_u32 s72, s71, 16384
    s_cmp_ge_u32 s72, 81920
    s_cselect_b32 s72, 81920, 0
    s_sub_u32 s72, 16384, s72
    ds_read_b128 v[16:19], v8 offset:8192
    v_add_u32 v8, s72, v8
    s_waitcnt lgkmcnt(7)
    v_mfma_f32_32x32x16_bf16 v[96:111], v[20:23], v[228:231], v[96:111]
    ds_read_b128 v[20:23], v9 offset:8192
    v_add_u32 v9, s72, v9
    s_waitcnt lgkmcnt(7)
    v_mfma_f32_32x32x16_bf16 v[96:111], v[24:27], v[232:235], v[96:111]
    ds_read_b128 v[24:27], v10 offset:8192
    v_add_u32 v10, s72, v10
    s_waitcnt lgkmcnt(7)
    v_mfma_f32_32x32x16_bf16 v[96:111], v[28:31], v[236:239], v[96:111]
    ds_read_b128 v[28:31], v11 offset:8192
    v_add_u32 v11, s72, v11
    s_waitcnt lgkmcnt(7)
    v_mfma_f32_32x32x16_bf16 v[96:111], v[160:163], v[240:243], v[96:111]
    ds_read_b128 v[160:163], v12 offset:8192
    v_add_u32 v12, s72, v12
    s_waitcnt lgkmcnt(7)
    v_mfma_f32_32x32x16_bf16 v[96:111], v[164:167], v[244:247], v[96:111]
    ds_read_b128 v[164:167], v13 offset:8192
    v_add_u32 v13, s72, v13
    s_waitcnt lgkmcnt(7)
    v_mfma_f32_32x32x16_bf16 v[96:111], v[168:171], v[248:251], v[96:111]
    ds_read_b128 v[168:171], v14 offset:8192
    v_add_u32 v14, s72, v14
    s_waitcnt lgkmcnt(7)
    v_mfma_f32_32x32x16_bf16 v[96:111], v[172:175], v[252:255], v[96:111]
    ds_read_b128 v[172:175], v15 offset:8192
    v_add_u32 v15, s72, v15
    s_waitcnt lgkmcnt(7)
    v_mfma_f32_32x32x16_bf16 v[112:127], v[16:19], v[224:227], 0
    ds_read_b128 v[16:19], v8
    s_waitcnt lgkmcnt(7)
    v_mfma_f32_32x32x16_bf16 v[112:127], v[20:23], v[228:231], v[112:127]
    ds_read_b128 v[20:23], v9
    s_waitcnt lgkmcnt(7)
    v_mfma_f32_32x32x16_bf16 v[112:127], v[24:27], v[232:235], v[112:127]
    ds_read_b128 v[24:27], v10
    s_waitcnt lgkmcnt(7)
    v_mfma_f32_32x32x16_bf16 v[112:127], v[28:31], v[236:239], v[112:127]
    ds_read_b128 v[28:31], v11
    s_waitcnt lgkmcnt(7)
    v_mfma_f32_32x32x16_bf16 v[112:127], v[160:163], v[240:243], v[112:127]
    ds_read_b128 v[160:163], v12
    s_waitcnt lgkmcnt(7)
    v_mfma_f32_32x32x16_bf16 v[112:127], v[164:167], v[244:247], v[112:127]
    ds_read_b128 v[164:167], v13
    s_waitcnt lgkmcnt(7)
    v_mfma_f32_32x32x16_bf16 v[112:127], v[168:171], v[248:251], v[112:127]
    ds_read_b128 v[168:171], v14
    s_waitcnt lgkmcnt(7)
    v_mfma_f32_32x32x16_bf16 v[112:127], v[172:175], v[252:255], v[112:127]
    s_waitcnt vmcnt(8)
    s_barrier
    s_add_u32 s9, s77, s71
    s_mov_b32 m0, s9
    s_nop 0
    buffer_load_dwordx4 v4, s[20:23], s73 offen nt lds
    buffer_load_dwordx4 v5, s[20:23], s73 offen offset:1024 nt lds
    buffer_load_dwordx4 v6, s[20:23], s73 offen offset:2048 nt lds
    buffer_load_dwordx4 v7, s[20:23], s73 offen offset:3072 nt lds
    s_add_u32 s73, s73, 16384
    s_add_u32 s71, s71, 16384
    s_cmp_eq_u32 s71, 81920
    s_cselect_b32 s71, 0, s71
    ds_read_b128 v[172:175], v15
    s_waitcnt lgkmcnt(7)
    v_mfma_f32_32x32x16_bf16 v[128:143], v[16:19], v[224:227], 0
    s_add_u32 s72, s71, 49152
    s_cmp_ge_u32 s72, 81920
    s_cselect_b32 s72, 81920, 0
    s_sub_u32 s72, 49152, s72
    v_max3_f32 v208, v96, v97, v98
    v_max3_f32 v208, v208, v99, v100
    ds_read_b128 v[16:19], v8 offset:8192
    v_add_u32 v8, s72, v8
    s_waitcnt lgkmcnt(7)
    v_mfma_f32_32x32x16_bf16 v[128:143], v[20:23], v[228:231], v[128:143]
    v_max3_f32 v208, v208, v101, v102
    v_max3_f32 v208, v208, v103, v104
    ds_read_b128 v[20:23], v9 offset:8192
    v_add_u32 v9, s72, v9
    s_waitcnt lgkmcnt(7)
    v_mfma_f32_32x32x16_bf16 v[128:143], v[24:27], v[232:235], v[128:143]
    v_max3_f32 v208, v208, v105, v106
    v_max3_f32 v208, v208, v107, v108
    ds_read_b128 v[24:27], v10 offset:8192
    v_add_u32 v10, s72, v10
    s_waitcnt lgkmcnt(7)
    v_mfma_f32_32x32x16_bf16 v[128:143], v[28:31], v[236:239], v[128:143]
    v_max3_f32 v208, v208, v109, v110
    v_max_f32 v208, v208, v111
    ds_read_b128 v[28:31], v11 offset:8192
    v_add_u32 v11, s72, v11
    s_waitcnt lgkmcnt(7)
    v_mfma_f32_32x32x16_bf16 v[128:143], v[160:163], v[240:243], v[128:143]
    v_max3_f32 v209, v112, v113, v114
    v_max3_f32 v209, v209, v115, v116
    ds_read_b128 v[160:163], v12 offset:8192
    v_add_u32 v12, s72, v12
    s_waitcnt lgkmcnt(7)
    v_mfma_f32_32x32x16_bf16 v[128:143], v[164:167], v[244:247], v[128:143]
    v_max3_f32 v209, v209, v117, v118
    v_max3_f32 v209, v209, v119, v120
    ds_read_b128 v[164:167], v13 offset:8192
    v_add_u32 v13, s72, v13
    s_waitcnt lgkmcnt(7)
    v_mfma_f32_32x32x16_bf16 v[128:143], v[168:171], v[248:251], v[128:143]
    v_max3_f32 v209, v209, v121, v122
    v_max3_f32 v209, v209, v123, v124
    ds_read_b128 v[168:171], v14 offset:8192
    v_add_u32 v14, s72, v14
    s_waitcnt lgkmcnt(7)
    v_mfma_f32_32x32x16_bf16 v[128:143], v[172:175], v[252:255], v[128:143]
    v_max3_f32 v209, v209, v125, v126
    v_max_f32 v209, v209, v127
    ds_read_b128 v[172:175], v15 offset:8192
    v_add_u32 v15, s72, v15
    s_waitcnt lgkmcnt(7)
    v_mfma_f32_32x32x16_bf16 v[144:159], v[16:19], v[224:227], 0
    ds_read_b64_tr_b16 v[16:17], v200
    ds_read_b64_tr_b16 v[18:19], v200 offset:1024
    s_waitcnt lgkmcnt(8)
    v_mfma_f32_32x32x16_bf16 v[144:159], v[20:23], v[228:231], v[144:159]
    ds_read_b64_tr_b16 v[20:21], v201
    ds_read_b64_tr_b16 v[22:23], v201 offset:1024
    s_waitcnt lgkmcnt(9)
    v_mfma_f32_32x32x16_bf16 v[144:159], v[24:27], v[232:235], v[144:159]
    ds_read_b64_tr_b16 v[24:25], v202
    ds_read_b64_tr_b16 v[26:27], v202 offset:1024
    s_waitcnt lgkmcnt(10)
    v_mfma_f32_32x32x16_bf16 v[144:159], v[28:31], v[236:239], v[144:159]
    v_max3_f32 v210, v128, v129, v130
    v_max3_f32 v210, v210, v131, v132
    ds_read_b64_tr_b16 v[28:29], v203
    ds_read_b64_tr_b16 v[30:31], v203 offset:1024
    s_waitcnt lgkmcnt(11)
    v_mfma_f32_32x32x16_bf16 v[144:159], v[160:163], v[240:243], v[144:159]
    v_max3_f32 v210, v210, v133, v134
    v_max3_f32 v210, v210, v135, v136
    ds_read_b64_tr_b16 v[160:161], v200 offset:4096
    ds_read_b64_tr_b16 v[162:163], v200 offset:5120
    s_waitcnt lgkmcnt(12)
    v_mfma_f32_32x32x16_bf16 v[144:159], v[164:167], v[244:247], v[144:159]
    v_max3_f32 v210, v210, v137, v138
    v_max3_f32 v210, v210, v139, v140
    ds_read_b64_tr_b16 v[164:165], v201 offset:4096
    ds_read_b64_tr_b16 v[166:167], v201 offset:5120
    s_waitcnt lgkmcnt(13)
    v_mfma_f32_32x32x16_bf16 v[144:159], v[168:171], v[248:251], v[144:159]
    v_max3_f32 v210, v210, v141, v142
    v_max_f32 v210, v210, v143
    ds_read_b64_tr_b16 v[168:169], v202 offset:4096
    ds_read_b64_tr_b16 v[170:171], v202 offset:5120
    s_waitcnt lgkmcnt(14)
    v_mfma_f32_32x32x16_bf16 v[144:159], v[172:175], v[252:255], v[144:159]
    s_waitcnt vmcnt(8)
    s_barrier
    s_add_u32 s9, s77, s71
    s_mov_b32 m0, s9
    s_nop 0
    buffer_load_dwordx4 v2, s[24:27], s74 offen nt lds
    buffer_load_dwordx4 v2, s[24:27], s74 offen offset:1024 nt lds
    buffer_load_dwordx4 v2, s[24:27], s74 offen offset:2048 nt lds
    buffer_load_dwordx4 v2, s[24:27], s74 offen offset:3072 nt lds
    s_add_u32 s74, s74, 16384
    s_add_u32 s71, s71, 16384
    s_cmp_eq_u32 s71, 81920
    s_cselect_b32 s71, 0, s71
    v_max3_f32 v211, v144, v145, v146
    v_max3_f32 v211, v211, v147, v148
    v_max3_f32 v211, v211, v149, v150
    v_max3_f32 v211, v211, v151, v152
    v_max3_f32 v211, v211, v153, v154
    v_max3_f32 v211, v211, v155, v156
    v_max3_f32 v211, v211, v157, v158
    v_max_f32 v211, v211, v159
    v_max3_f32 v208, v208, v209, v210
    v_max_f32 v208, v208, v211
    v_mov_b32 v209, v208
    s_nop 1
    v_permlane32_swap_b32 v208, v209
    v_max_f32 v208, v208, v209
    v_sub_f32 v209, v208, v204
    v_cmp_lt_f32 vcc, s62, v209
    s_cbranch_vccz L_norsa
    v_max_f32 v208, v208, v204
    v_sub_f32 v209, v204, v208
    v_mul_f32 v209, s76, v209
    v_exp_f32 v207, v209
    v_mul_f32 v206, s76, v208
    v_mov_b32 v204, v208
    v_mul_f32 v205, v205, v207
    v_mul_f32 v212, v212, v207
    v_mul_f32 v32, v207, v32
    v_mul_f32 v33, v207, v33
    v_mul_f32 v34, v207, v34
    v_mul_f32 v35, v207, v35
    v_mul_f32 v36, v207, v36
    v_mul_f32 v37, v207, v37
    v_mul_f32 v38, v207, v38
    v_mul_f32 v39, v207, v39
    v_mul_f32 v40, v207, v40
    v_mul_f32 v41, v207, v41
    v_mul_f32 v42, v207, v42
    v_mul_f32 v43, v207, v43
    v_mul_f32 v44, v207, v44
    v_mul_f32 v45, v207, v45
    v_mul_f32 v46, v207, v46
    v_mul_f32 v47, v207, v47
    v_mul_f32 v48, v207, v48
    v_mul_f32 v49, v207, v49
    v_mul_f32 v50, v207, v50
    v_mul_f32 v51, v207, v51
    v_mul_f32 v52, v207, v52
    v_mul_f32 v53, v207, v53
    v_mul_f32 v54, v207, v54
    v_mul_f32 v55, v207, v55
    v_mul_f32 v56, v207, v56
    v_mul_f32 v57, v207, v57
    v_mul_f32 v58, v207, v58
    v_mul_f32 v59, v207, v59
    v_mul_f32 v60, v207, v60
    v_mul_f32 v61, v207, v61
    v_mul_f32 v62, v207, v62
    v_mul_f32 v63, v207, v63
    v_mul_f32 v64, v207, v64
    v_mul_f32 v65, v207, v65
    v_mul_f32 v66, v207, v66
    v_mul_f32 v67, v207, v67
    v_mul_f32 v68, v207, v68
    v_mul_f32 v69, v207, v69
    v_mul_f32 v70, v207, v70
    v_mul_f32 v71, v207, v71
    v_mul_f32 v72, v207, v72
    v_mul_f32 v73, v207, v73
    v_mul_f32 v74, v207, v74
    v_mul_f32 v75, v207, v75
    v_mul_f32 v76, v207, v76
    v_mul_f32 v77, v207, v77
    v_mul_f32 v78, v207, v78
    v_mul_f32 v79, v207, v79
    v_mul_f32 v80, v207, v80
    v_mul_f32 v81, v207, v81
    v_mul_f32 v82, v207, v82
    v_mul_f32 v83, v207, v83
    v_mul_f32 v84, v207, v84
    v_mul_f32 v85, v207, v85
    v_mul_f32 v86, v207, v86
    v_mul_f32 v87, v207, v87
    v_mul_f32 v88, v207, v88
    v_mul_f32 v89, v207, v89
    v_mul_f32 v90, v207, v90
    v_mul_f32 v91, v207, v91
    v_mul_f32 v92, v207, v92
    v_mul_f32 v93, v207, v93
    v_mul_f32 v94, v207, v94
    v_mul_f32 v95, v207, v95
L_norsa:
    v_fma_f32 v96, v96, s76, -v206
    v_fma_f32 v97, v97, s76, -v206
    v_fma_f32 v98, v98, s76, -v206
    v_fma_f32 v99, v99, s76, -v206
    v_exp_f32 v96, v96
    v_exp_f32 v97, v97
    v_exp_f32 v98, v98
    v_exp_f32 v99, v99
    v_add_f32 v205, v205, v96
    v_add_f32 v212, v212, v97
    v_add_f32 v205, v205, v98
    v_add_f32 v212, v212, v99
    v_cvt_pk_bf16_f32 v96, v96, v97
    v_cvt_pk_bf16_f32 v97, v98, v99
    v_fma_f32 v100, v100, s76, -v206
    v_fma_f32 v101, v101, s76, -v206
    v_fma_f32 v102, v102, s76, -v206
    v_fma_f32 v103, v103, s76, -v206
    v_exp_f32 v100, v100
    v_exp_f32 v101, v101
    v_exp_f32 v102, v102
    v_exp_f32 v103, v103
    v_add_f32 v205, v205, v100
    v_add_f32 v212, v212, v101
    v_add_f32 v205, v205, v102
    v_add_f32 v212, v212, v103
    v_cvt_pk_bf16_f32 v98, v100, v101
    v_cvt_pk_bf16_f32 v99, v102, v103
    ds_read_b64_tr_b16 v[172:173], v203 offset:4096
    ds_read_b64_tr_b16 v[174:175], v203 offset:5120
    s_waitcnt lgkmcnt(14)
    v_mfma_f32_32x32x16_bf16 v[32:47], v[16:19], v[96:99], v[32:47]
    s_add_u32 s72, s71, 16384
    s_cmp_ge_u32 s72, 81920
    s_cselect_b32 s72, 81920, 0
    s_sub_u32 s72, 16384, s72
    v_fma_f32 v104, v104, s76, -v206
    v_fma_f32 v105, v105, s76, -v206
    v_fma_f32 v106, v106, s76, -v206
    v_fma_f32 v107, v107, s76, -v206
    v_exp_f32 v104, v104
    v_exp_f32 v105, v105
    v_exp_f32 v106, v106
    ds_read_b64_tr_b16 v[16:17], v200 offset:8192
    ds_read_b64_tr_b16 v[18:19], v200 offset:9216
    s_waitcnt lgkmcnt(14)
    v_mfma_f32_32x32x16_bf16 v[48:63], v[20:23], v[96:99], v[48:63]
    v_exp_f32 v107, v107
    v_add_f32 v205, v205, v104
    v_add_f32 v212, v212, v105
    v_add_f32 v205, v205, v106
    v_add_f32 v212, v212, v107
    v_cvt_pk_bf16_f32 v100, v104, v105
    v_cvt_pk_bf16_f32 v101, v106, v107
    ds_read_b64_tr_b16 v[20:21], v201 offset:8192
    ds_read_b64_tr_b16 v[22:23], v201 offset:9216
    s_waitcnt lgkmcnt(14)
    v_mfma_f32_32x32x16_bf16 v[64:79], v[24:27], v[96:99], v[64:79]
    v_fma_f32 v108, v108, s76, -v206
    v_fma_f32 v109, v109, s76, -v206
    v_fma_f32 v110, v110, s76, -v206
    v_fma_f32 v111, v111, s76, -v206
    v_exp_f32 v108, v108
    v_exp_f32 v109, v109
    v_exp_f32 v110, v110
    ds_read_b64_tr_b16 v[24:25], v202 offset:8192
    ds_read_b64_tr_b16 v[26:27], v202 offset:9216
    s_waitcnt lgkmcnt(14)
    v_mfma_f32_32x32x16_bf16 v[80:95], v[28:31], v[96:99], v[80:95]
    v_exp_f32 v111, v111
    v_add_f32 v205, v205, v108
    v_add_f32 v212, v212, v109
    v_add_f32 v205, v205, v110
    v_add_f32 v212, v212, v111
    v_cvt_pk_bf16_f32 v102, v108, v109
    v_cvt_pk_bf16_f32 v103, v110, v111
    ds_read_b64_tr_b16 v[28:29], v203 offset:8192
    ds_read_b64_tr_b16 v[30:31], v203 offset:9216
    s_waitcnt lgkmcnt(14)
    v_mfma_f32_32x32x16_bf16 v[32:47], v[160:163], v[100:103], v[32:47]
    v_fma_f32 v112, v112, s76, -v206
    v_fma_f32 v113, v113, s76, -v206
    v_fma_f32 v114, v114, s76, -v206
    v_fma_f32 v115, v115, s76, -v206
    v_exp_f32 v112, v112
    v_exp_f32 v113, v113
    v_exp_f32 v114, v114
    ds_read_b64_tr_b16 v[160:161], v200 offset:12288
    ds_read_b64_tr_b16 v[162:163], v200 offset:13312
    v_add_u32 v200, s72, v200
    s_waitcnt lgkmcnt(14)
    v_mfma_f32_32x32x16_bf16 v[48:63], v[164:167], v[100:103], v[48:63]
    v_exp_f32 v115, v115
    v_add_f32 v205, v205, v112
    v_add_f32 v212, v212, v113
    v_add_f32 v205, v205, v114
    v_add_f32 v212, v212, v115
    v_cvt_pk_bf16_f32 v112, v112, v113
    v_cvt_pk_bf16_f32 v113, v114, v115
    ds_read_b64_tr_b16 v[164:165], v201 offset:12288
    ds_read_b64_tr_b16 v[166:167], v201 offset:13312
    v_add_u32 v201, s72, v201
    s_waitcnt lgkmcnt(14)
    v_mfma_f32_32x32x16_bf16 v[64:79], v[168:171], v[100:103], v[64:79]
    v_fma_f32 v116, v116, s76, -v206
    v_fma_f32 v117, v117, s76, -v206
    v_fma_f32 v118, v118, s76, -v206
    v_fma_f32 v119, v119, s76, -v206
    v_exp_f32 v116, v116
    v_exp_f32 v117, v117
    v_exp_f32 v118, v118
    ds_read_b64_tr_b16 v[168:169], v202 offset:12288
    ds_read_b64_tr_b16 v[170:171], v202 offset:13312
    v_add_u32 v202, s72, v202
    s_waitcnt lgkmcnt(14)
    v_mfma_f32_32x32x16_bf16 v[80:95], v[172:175], v[100:103], v[80:95]
    v_exp_f32 v119, v119
    v_add_f32 v205, v205, v116
    v_add_f32 v212, v212, v117
    v_add_f32 v205, v205, v118
    v_add_f32 v212, v212, v119
    v_cvt_pk_bf16_f32 v114, v116, v117
    v_cvt_pk_bf16_f32 v115, v118, v119
    ds_read_b64_tr_b16 v[172:173], v203 offset:12288
    ds_read_b64_tr_b16 v[174:175], v203 offset:13312
    v_add_u32 v203, s72, v203
    s_waitcnt lgkmcnt(14)
    v_mfma_f32_32x32x16_bf16 v[32:47], v[16:19], v[112:115], v[32:47]
    v_fma_f32 v120, v120, s76, -v206
    v_fma_f32 v121, v121, s76, -v206
    v_fma_f32 v122, v122, s76, -v206
    v_fma_f32 v123, v123, s76, -v206
    v_exp_f32 v120, v120
    v_exp_f32 v121, v121
    v_exp_f32 v122, v122
    ds_read_b64_tr_b16 v[16:17], v200
    ds_read_b64_tr_b16 v[18:19], v200 offset:1024
    s_waitcnt lgkmcnt(14)
    v_mfma_f32_32x32x16_bf16 v[48:63], v[20:23], v[112:115], v[48:63]
    v_exp_f32 v123, v123
    v_add_f32 v205, v205, v120
    v_add_f32 v212, v212, v121
    v_add_f32 v205, v205, v122
    v_add_f32 v212, v212, v123
    v_cvt_pk_bf16_f32 v116, v120, v121
    v_cvt_pk_bf16_f32 v117, v122, v123
    ds_read_b64_tr_b16 v[20:21], v201
    ds_read_b64_tr_b16 v[22:23], v201 offset:1024
    s_waitcnt lgkmcnt(14)
    v_mfma_f32_32x32x16_bf16 v[64:79], v[24:27], v[112:115], v[64:79]
    v_fma_f32 v124, v124, s76, -v206
    v_fma_f32 v125, v125, s76, -v206
    v_fma_f32 v126, v126, s76, -v206
    v_fma_f32 v127, v127, s76, -v206
    v_exp_f32 v124, v124
    v_exp_f32 v125, v125
    v_exp_f32 v126, v126
    ds_read_b64_tr_b16 v[24:25], v202
    ds_read_b64_tr_b16 v[26:27], v202 offset:1024
    s_waitcnt lgkmcnt(14)
    v_mfma_f32_32x32x16_bf16 v[80:95], v[28:31], v[112:115], v[80:95]
    v_exp_f32 v127, v127
    v_add_f32 v205, v205, v124
    v_add_f32 v212, v212, v125
    v_add_f32 v205, v205, v126
    v_add_f32 v212, v212, v127
    v_cvt_pk_bf16_f32 v118, v124, v125
    v_cvt_pk_bf16_f32 v119, v126, v127
    ds_read_b64_tr_b16 v[28:29], v203
    ds_read_b64_tr_b16 v[30:31], v203 offset:1024
    s_waitcnt lgkmcnt(14)
    v_mfma_f32_32x32x16_bf16 v[32:47], v[160:163], v[116:119], v[32:47]
    v_fma_f32 v128, v128, s76, -v206
    v_fma_f32 v129, v129, s76, -v206
    v_fma_f32 v130, v130, s76, -v206
    v_fma_f32 v131, v131, s76, -v206
    v_exp_f32 v128, v128
    v_exp_f32 v129, v129
    v_exp_f32 v130, v130
    ds_read_b64_tr_b16 v[160:161], v200 offset:4096
    ds_read_b64_tr_b16 v[162:163], v200 offset:5120
    s_waitcnt lgkmcnt(14)
    v_mfma_f32_32x32x16_bf16 v[48:63], v[164:167], v[116:119], v[48:63]
    v_exp_f32 v131, v131
    v_add_f32 v205, v205, v128
    v_add_f32 v212, v212, v129
    v_add_f32 v205, v205, v130
    v_add_f32 v212, v212, v131
    v_cvt_pk_bf16_f32 v128, v128, v129
    v_cvt_pk_bf16_f32 v129, v130, v131
    ds_read_b64_tr_b16 v[164:165], v201 offset:4096
    ds_read_b64_tr_b16 v[166:167], v201 offset:5120
    s_waitcnt lgkmcnt(14)
    v_mfma_f32_32x32x16_bf16 v[64:79], v[168:171], v[116:119], v[64:79]
    v_fma_f32 v132, v132, s76, -v206
    v_fma_f32 v133, v133, s76, -v206
    v_fma_f32 v134, v134, s76, -v206
    v_fma_f32 v135, v135, s76, -v206
    v_exp_f32 v132, v132
    v_exp_f32 v133, v133
    v_exp_f32 v134, v134
    ds_read_b64_tr_b16 v[168:169], v202 offset:4096
    ds_read_b64_tr_b16 v[170:171], v202 offset:5120
    s_waitcnt lgkmcnt(14)
    v_mfma_f32_32x32x16_bf16 v[80:95], v[172:175], v[116:119], v[80:95]
    v_exp_f32 v135, v135
    v_add_f32 v205, v205, v132
    v_add_f32 v212, v212, v133
    v_add_f32 v205, v205, v134
    v_add_f32 v212, v212, v135
    v_cvt_pk_bf16_f32 v130, v132, v133
    v_cvt_pk_bf16_f32 v131, v134, v135
    s_waitcnt vmcnt(8)
    s_barrier
    s_add_u32 s9, s77, s71
    s_mov_b32 m0, s9
    s_nop 0
    buffer_load_dwordx4 v2, s[24:27], s74 offen nt lds
    buffer_load_dwordx4 v2, s[24:27], s74 offen offset:1024 nt lds
    buffer_load_dwordx4 v2, s[24:27], s74 offen offset:2048 nt lds
    buffer_load_dwordx4 v2, s[24:27], s74 offen offset:3072 nt lds
    s_add_u32 s74, s74, 16384
    s_add_u32 s71, s71, 16384
    s_cmp_eq_u32 s71, 81920
    s_cselect_b32 s71, 0, s71
    ds_read_b64_tr_b16 v[172:173], v203 offset:4096
    ds_read_b64_tr_b16 v[174:175], v203 offset:5120
    s_waitcnt lgkmcnt(14)
    v_mfma_f32_32x32x16_bf16 v[32:47], v[16:19], v[128:131], v[32:47]
    s_add_u32 s72, s71, 49152
    s_cmp_ge_u32 s72, 81920
    s_cselect_b32 s72, 81920, 0
    s_sub_u32 s72, 49152, s72
    v_fma_f32 v136, v136, s76, -v206
    v_fma_f32 v137, v137, s76, -v206
    v_fma_f32 v138, v138, s76, -v206
    v_fma_f32 v139, v139, s76, -v206
    v_exp_f32 v136, v136
    v_exp_f32 v137, v137
    v_exp_f32 v138, v138
    ds_read_b64_tr_b16 v[16:17], v200 offset:8192
    ds_read_b64_tr_b16 v[18:19], v200 offset:9216
    s_waitcnt lgkmcnt(14)
    v_mfma_f32_32x32x16_bf16 v[48:63], v[20:23], v[128:131], v[48:63]
    v_exp_f32 v139, v139
    v_add_f32 v205, v205, v136
    v_add_f32 v212, v212, v137
    v_add_f32 v205, v205, v138
    v_add_f32 v212, v212, v139
    v_cvt_pk_bf16_f32 v132, v136, v137
    v_cvt_pk_bf16_f32 v133, v138, v139
    ds_read_b64_tr_b16 v[20:21], v201 offset:8192
    ds_read_b64_tr_b16 v[22:23], v201 offset:9216
    s_waitcnt lgkmcnt(14)
    v_mfma_f32_32x32x16_bf16 v[64:79], v[24:27], v[128:131], v[64:79]
    v_fma_f32 v140, v140, s76, -v206
    v_fma_f32 v141, v141, s76, -v206
    v_fma_f32 v142, v142, s76, -v206
    v_fma_f32 v143, v143, s76, -v206
    v_exp_f32 v140, v140
    v_exp_f32 v141, v141
    v_exp_f32 v142, v142
    ds_read_b64_tr_b16 v[24:25], v202 offset:8192
    ds_read_b64_tr_b16 v[26:27], v202 offset:9216
    s_waitcnt lgkmcnt(14)
    v_mfma_f32_32x32x16_bf16 v[80:95], v[28:31], v[128:131], v[80:95]
    v_exp_f32 v143, v143
    v_add_f32 v205, v205, v140
    v_add_f32 v212, v212, v141
    v_add_f32 v205, v205, v142
    v_add_f32 v212, v212, v143
    v_cvt_pk_bf16_f32 v134, v140, v141
    v_cvt_pk_bf16_f32 v135, v142, v143
    ds_read_b64_tr_b16 v[28:29], v203 offset:8192
    ds_read_b64_tr_b16 v[30:31], v203 offset:9216
    s_waitcnt lgkmcnt(14)
    v_mfma_f32_32x32x16_bf16 v[32:47], v[160:163], v[132:135], v[32:47]
    v_fma_f32 v144, v144, s76, -v206
    v_fma_f32 v145, v145, s76, -v206
    v_fma_f32 v146, v146, s76, -v206
    v_fma_f32 v147, v147, s76, -v206
    v_exp_f32 v144, v144
    v_exp_f32 v145, v145
    v_exp_f32 v146, v146
    ds_read_b64_tr_b16 v[160:161], v200 offset:12288
    ds_read_b64_tr_b16 v[162:163], v200 offset:13312
    v_add_u32 v200, s72, v200
    s_waitcnt lgkmcnt(14)
    v_mfma_f32_32x32x16_bf16 v[48:63], v[164:167], v[132:135], v[48:63]
    v_exp_f32 v147, v147
    v_add_f32 v205, v205, v144
    v_add_f32 v212, v212, v145
    v_add_f32 v205, v205, v146
    v_add_f32 v212, v212, v147
    v_cvt_pk_bf16_f32 v144, v144, v145
    v_cvt_pk_bf16_f32 v145, v146, v147
    ds_read_b64_tr_b16 v[164:165], v201 offset:12288
    ds_read_b64_tr_b16 v[166:167], v201 offset:13312
    v_add_u32 v201, s72, v201
    s_waitcnt lgkmcnt(14)
    v_mfma_f32_32x32x16_bf16 v[64:79], v[168:171], v[132:135], v[64:79]
    v_fma_f32 v148, v148, s76, -v206
    v_fma_f32 v149, v149, s76, -v206
    v_fma_f32 v150, v150, s76, -v206
    v_fma_f32 v151, v151, s76, -v206
    v_exp_f32 v148, v148
    v_exp_f32 v149, v149
    v_exp_f32 v150, v150
    ds_read_b64_tr_b16 v[168:169], v202 offset:12288
    ds_read_b64_tr_b16 v[170:171], v202 offset:13312
    v_add_u32 v202, s72, v202
    s_waitcnt lgkmcnt(14)
    v_mfma_f32_32x32x16_bf16 v[80:95], v[172:175], v[132:135], v[80:95]
    v_exp_f32 v151, v151
    v_add_f32 v205, v205, v148
    v_add_f32 v212, v212, v149
    v_add_f32 v205, v205, v150
    v_add_f32 v212, v212, v151
    v_cvt_pk_bf16_f32 v146, v148, v149
    v_cvt_pk_bf16_f32 v147, v150, v151
    ds_read_b64_tr_b16 v[172:173], v203 offset:12288
    ds_read_b64_tr_b16 v[174:175], v203 offset:13312
    v_add_u32 v203, s72, v203
    s_waitcnt lgkmcnt(14)
    v_mfma_f32_32x32x16_bf16 v[32:47], v[16:19], v[144:147], v[32:47]
    v_fma_f32 v152, v152, s76, -v206
    v_fma_f32 v153, v153, s76, -v206
    v_fma_f32 v154, v154, s76, -v206
    v_fma_f32 v155, v155, s76, -v206
    v_exp_f32 v152, v152
    v_exp_f32 v153, v153
    v_exp_f32 v154, v154
    ds_read_b128 v[16:19], v8
    s_waitcnt lgkmcnt(13)
    v_mfma_f32_32x32x16_bf16 v[48:63], v[20:23], v[144:147], v[48:63]
    v_exp_f32 v155, v155
    v_add_f32 v205, v205, v152
    v_add_f32 v212, v212, v153
    v_add_f32 v205, v205, v154
    v_add_f32 v212, v212, v155
    v_cvt_pk_bf16_f32 v148, v152, v153
    v_cvt_pk_bf16_f32 v149, v154, v155
    ds_read_b128 v[20:23], v9
    s_waitcnt lgkmcnt(12)
    v_mfma_f32_32x32x16_bf16 v[64:79], v[24:27], v[144:147], v[64:79]
    v_fma_f32 v156, v156, s76, -v206
    v_fma_f32 v157, v157, s76, -v206
    v_fma_f32 v158, v158, s76, -v206
    v_fma_f32 v159, v159, s76, -v206
    v_exp_f32 v156, v156
    v_exp_f32 v157, v157
    v_exp_f32 v158, v158
    ds_read_b128 v[24:27], v10
    s_waitcnt lgkmcnt(11)
    v_mfma_f32_32x32x16_bf16 v[80:95], v[28:31], v[144:147], v[80:95]
    v_exp_f32 v159, v159
    v_add_f32 v205, v205, v156
    v_add_f32 v212, v212, v157
    v_add_f32 v205, v205, v158
    v_add_f32 v212, v212, v159
    v_cvt_pk_bf16_f32 v150, v156, v157
    v_cvt_pk_bf16_f32 v151, v158, v159
    ds_read_b128 v[28:31], v11
    s_waitcnt lgkmcnt(10)
    v_mfma_f32_32x32x16_bf16 v[32:47], v[160:163], v[148:151], v[32:47]
    ds_read_b128 v[160:163], v12
    s_waitcnt lgkmcnt(9)
    v_mfma_f32_32x32x16_bf16 v[48:63], v[164:167], v[148:151], v[48:63]
    ds_read_b128 v[164:167], v13
    s_waitcnt lgkmcnt(8)
    v_mfma_f32_32x32x16_bf16 v[64:79], v[168:171], v[148:151], v[64:79]
    ds_read_b128 v[168:171], v14
    s_waitcnt lgkmcnt(7)
    v_mfma_f32_32x32x16_bf16 v[80:95], v[172:175], v[148:151], v[80:95]
    s_waitcnt vmcnt(8)
    s_barrier
    s_add_u32 s9, s77, s71
    s_mov_b32 m0, s9
    s_nop 0
    buffer_load_dwordx4 v4, s[20:23], s73 offen nt lds
    buffer_load_dwordx4 v5, s[20:23], s73 offen offset:1024 nt lds
    buffer_load_dwordx4 v6, s[20:23], s73 offen offset:2048 nt lds
    buffer_load_dwordx4 v7, s[20:23], s73 offen offset:3072 nt lds
    s_add_u32 s73, s73, 16384
    s_add_u32 s71, s71, 16384
    s_cmp_eq_u32 s71, 81920
    s_cselect_b32 s71, 0, s71
    s_add_u32 s75, s75, 1
    s_cmp_lt_u32 s75, 3
    s_cbranch_scc1 L_loop
    s_lshr_b32 s10, s2, 3
    s_and_b32 s9, s10, 8
    s_cmp_lg_u32 s9, 0
    s_cbranch_scc1 L_nowopf
    s_lshr_b32 s9, s10, 4
    s_lshl_b32 s9, s9, 3
    s_and_b32 s10, s10, 7
    s_add_u32 s10, s10, s9
    s_and_b32 s9, s2, 3
    s_lshl_b32 s9, s9, 4
    s_add_u32 s9, s9, s10
    s_mul_i32 s9, s9, 10
    s_add_u32 s9, s9, s3
    s_lshl_b32 s9, s9, 13
    v_lshlrev_b32 v0, 7, v1
    buffer_load_dword v3, v0, s[36:39], s9 offen
    s_cmp_ge_u32 s3, 2
    s_cbranch_scc1 L_nowopf
    s_add_u32 s9, s9, 65536
    buffer_load_dword v3, v0, s[36:39], s9 offen
L_nowopf:
    ds_read_b128 v[172:175], v15
    s_waitcnt lgkmcnt(7)
    v_mfma_f32_32x32x16_bf16 v[96:111], v[16:19], v[224:227], 0
    s_add_u32 s72, s71, 16384
    s_cmp_ge_u32 s72, 81920
    s_cselect_b32 s72, 81920, 0
    s_sub_u32 s72, 16384, s72
    ds_read_b128 v[16:19], v8 offset:8192
    v_add_u32 v8, s72, v8
    s_waitcnt lgkmcnt(7)
    v_mfma_f32_32x32x16_bf16 v[96:111], v[20:23], v[228:231], v[96:111]
    ds_read_b128 v[20:23], v9 offset:8192
    v_add_u32 v9, s72, v9
    s_waitcnt lgkmcnt(7)
    v_mfma_f32_32x32x16_bf16 v[96:111], v[24:27], v[232:235], v[96:111]
    ds_read_b128 v[24:27], v10 offset:8192
    v_add_u32 v10, s72, v10
    s_waitcnt lgkmcnt(7)
    v_mfma_f32_32x32x16_bf16 v[96:111], v[28:31], v[236:239], v[96:111]
    ds_read_b128 v[28:31], v11 offset:8192
    v_add_u32 v11, s72, v11
    s_waitcnt lgkmcnt(7)
    v_mfma_f32_32x32x16_bf16 v[96:111], v[160:163], v[240:243], v[96:111]
    ds_read_b128 v[160:163], v12 offset:8192
    v_add_u32 v12, s72, v12
    s_waitcnt lgkmcnt(7)
    v_mfma_f32_32x32x16_bf16 v[96:111], v[164:167], v[244:247], v[96:111]
    ds_read_b128 v[164:167], v13 offset:8192
    v_add_u32 v13, s72, v13
    s_waitcnt lgkmcnt(7)
    v_mfma_f32_32x32x16_bf16 v[96:111], v[168:171], v[248:251], v[96:111]
    ds_read_b128 v[168:171], v14 offset:8192
    v_add_u32 v14, s72, v14
    s_waitcnt lgkmcnt(7)
    v_mfma_f32_32x32x16_bf16 v[96:111], v[172:175], v[252:255], v[96:111]
    ds_read_b128 v[172:175], v15 offset:8192
    v_add_u32 v15, s72, v15
    s_waitcnt lgkmcnt(7)
    v_mfma_f32_32x32x16_bf16 v[112:127], v[16:19], v[224:227], 0
    ds_read_b128 v[16:19], v8
    s_waitcnt lgkmcnt(7)
    v_mfma_f32_32x32x16_bf16 v[112:127], v[20:23], v[228:231], v[112:127]
    ds_read_b128 v[20:23], v9
    s_waitcnt lgkmcnt(7)
    v_mfma_f32_32x32x16_bf16 v[112:127], v[24:27], v[232:235], v[112:127]
    ds_read_b128 v[24:27], v10
    s_waitcnt lgkmcnt(7)
    v_mfma_f32_32x32x16_bf16 v[112:127], v[28:31], v[236:239], v[112:127]
    ds_read_b128 v[28:31], v11
    s_waitcnt lgkmcnt(7)
    v_mfma_f32_32x32x16_bf16 v[112:127], v[160:163], v[240:243], v[112:127]
    ds_read_b128 v[160:163], v12
    s_waitcnt lgkmcnt(7)
    v_mfma_f32_32x32x16_bf16 v[112:127], v[164:167], v[244:247], v[112:127]
    ds_read_b128 v[164:167], v13
    s_waitcnt lgkmcnt(7)
    v_mfma_f32_32x32x16_bf16 v[112:127], v[168:171], v[248:251], v[112:127]
    ds_read_b128 v[168:171], v14
    s_waitcnt lgkmcnt(7)
    v_mfma_f32_32x32x16_bf16 v[112:127], v[172:175], v[252:255], v[112:127]
    s_waitcnt vmcnt(8)
    s_barrier
    s_add_u32 s71, s71, 16384
    s_cmp_eq_u32 s71, 81920
    s_cselect_b32 s71, 0, s71
    ds_read_b128 v[172:175], v15
    s_waitcnt lgkmcnt(7)
    v_mfma_f32_32x32x16_bf16 v[128:143], v[16:19], v[224:227], 0
    s_add_u32 s72, s71, 49152
    s_cmp_ge_u32 s72, 81920
    s_cselect_b32 s72, 81920, 0
    s_sub_u32 s72, 49152, s72
    v_max3_f32 v208, v96, v97, v98
    v_max3_f32 v208, v208, v99, v100
    ds_read_b128 v[16:19], v8 offset:8192
    v_add_u32 v8, s72, v8
    s_waitcnt lgkmcnt(7)
    v_mfma_f32_32x32x16_bf16 v[128:143], v[20:23], v[228:231], v[128:143]
    v_max3_f32 v208, v208, v101, v102
    v_max3_f32 v208, v208, v103, v104
    ds_read_b128 v[20:23], v9 offset:8192
    v_add_u32 v9, s72, v9
    s_waitcnt lgkmcnt(7)
    v_mfma_f32_32x32x16_bf16 v[128:143], v[24:27], v[232:235], v[128:143]
    v_max3_f32 v208, v208, v105, v106
    v_max3_f32 v208, v208, v107, v108
    ds_read_b128 v[24:27], v10 offset:8192
    v_add_u32 v10, s72, v10
    s_waitcnt lgkmcnt(7)
    v_mfma_f32_32x32x16_bf16 v[128:143], v[28:31], v[236:239], v[128:143]
    v_max3_f32 v208, v208, v109, v110
    v_max_f32 v208, v208, v111
    ds_read_b128 v[28:31], v11 offset:8192
    v_add_u32 v11, s72, v11
    s_waitcnt lgkmcnt(7)
    v_mfma_f32_32x32x16_bf16 v[128:143], v[160:163], v[240:243], v[128:143]
    v_max3_f32 v209, v112, v113, v114
    v_max3_f32 v209, v209, v115, v116
    ds_read_b128 v[160:163], v12 offset:8192
    v_add_u32 v12, s72, v12
    s_waitcnt lgkmcnt(7)
    v_mfma_f32_32x32x16_bf16 v[128:143], v[164:167], v[244:247], v[128:143]
    v_max3_f32 v209, v209, v117, v118
    v_max3_f32 v209, v209, v119, v120
    ds_read_b128 v[164:167], v13 offset:8192
    v_add_u32 v13, s72, v13
    s_waitcnt lgkmcnt(7)
    v_mfma_f32_32x32x16_bf16 v[128:143], v[168:171], v[248:251], v[128:143]
    v_max3_f32 v209, v209, v121, v122
    v_max3_f32 v209, v209, v123, v124
    ds_read_b128 v[168:171], v14 offset:8192
    v_add_u32 v14, s72, v14
    s_waitcnt lgkmcnt(7)
    v_mfma_f32_32x32x16_bf16 v[128:143], v[172:175], v[252:255], v[128:143]
    v_max3_f32 v209, v209, v125, v126
    v_max_f32 v209, v209, v127
    ds_read_b128 v[172:175], v15 offset:8192
    v_add_u32 v15, s72, v15
    s_waitcnt lgkmcnt(7)
    v_mfma_f32_32x32x16_bf16 v[144:159], v[16:19], v[224:227], 0
    ds_read_b64_tr_b16 v[16:17], v200
    ds_read_b64_tr_b16 v[18:19], v200 offset:1024
    s_waitcnt lgkmcnt(8)
    v_mfma_f32_32x32x16_bf16 v[144:159], v[20:23], v[228:231], v[144:159]
    ds_read_b64_tr_b16 v[20:21], v201
    ds_read_b64_tr_b16 v[22:23], v201 offset:1024
    s_waitcnt lgkmcnt(9)
    v_mfma_f32_32x32x16_bf16 v[144:159], v[24:27], v[232:235], v[144:159]
    ds_read_b64_tr_b16 v[24:25], v202
    ds_read_b64_tr_b16 v[26:27], v202 offset:1024
    s_waitcnt lgkmcnt(10)
    v_mfma_f32_32x32x16_bf16 v[144:159], v[28:31], v[236:239], v[144:159]
    v_max3_f32 v210, v128, v129, v130
    v_max3_f32 v210, v210, v131, v132
    ds_read_b64_tr_b16 v[28:29], v203
    ds_read_b64_tr_b16 v[30:31], v203 offset:1024
    s_waitcnt lgkmcnt(11)
    v_mfma_f32_32x32x16_bf16 v[144:159], v[160:163], v[240:243], v[144:159]
    v_max3_f32 v210, v210, v133, v134
    v_max3_f32 v210, v210, v135, v136
    ds_read_b64_tr_b16 v[160:161], v200 offset:4096
    ds_read_b64_tr_b16 v[162:163], v200 offset:5120
    s_waitcnt lgkmcnt(12)
    v_mfma_f32_32x32x16_bf16 v[144:159], v[164:167], v[244:247], v[144:159]
    v_max3_f32 v210, v210, v137, v138
    v_max3_f32 v210, v210, v139, v140
    ds_read_b64_tr_b16 v[164:165], v201 offset:4096
    ds_read_b64_tr_b16 v[166:167], v201 offset:5120
    s_waitcnt lgkmcnt(13)
    v_mfma_f32_32x32x16_bf16 v[144:159], v[168:171], v[248:251], v[144:159]
    v_max3_f32 v210, v210, v141, v142
    v_max_f32 v210, v210, v143
    ds_read_b64_tr_b16 v[168:169], v202 offset:4096
    ds_read_b64_tr_b16 v[170:171], v202 offset:5120
    s_waitcnt lgkmcnt(14)
    v_mfma_f32_32x32x16_bf16 v[144:159], v[172:175], v[252:255], v[144:159]
    s_waitcnt vmcnt(4)
    s_barrier
    s_add_u32 s71, s71, 16384
    s_cmp_eq_u32 s71, 81920
    s_cselect_b32 s71, 0, s71
    s_nop 6
    v_max3_f32 v211, v144, v145, v146
    v_max3_f32 v211, v211, v147, v148
    v_max3_f32 v211, v211, v149, v150
    v_max3_f32 v211, v211, v151, v152
    v_max3_f32 v211, v211, v153, v154
    v_max3_f32 v211, v211, v155, v156
    v_max3_f32 v211, v211, v157, v158
    v_max_f32 v211, v211, v159
    v_max3_f32 v208, v208, v209, v210
    v_max_f32 v208, v208, v211
    v_mov_b32 v209, v208
    s_nop 1
    v_permlane32_swap_b32 v208, v209
    v_max_f32 v208, v208, v209
    v_sub_f32 v209, v208, v204
    v_cmp_lt_f32 vcc, s62, v209
    s_cbranch_vccz L_norsb
    v_max_f32 v208, v208, v204
    v_sub_f32 v209, v204, v208
    v_mul_f32 v209, s76, v209
    v_exp_f32 v207, v209
    v_mul_f32 v206, s76, v208
    v_mov_b32 v204, v208
    v_mul_f32 v205, v205, v207
    v_mul_f32 v212, v212, v207
    v_mul_f32 v32, v207, v32
    v_mul_f32 v33, v207, v33
    v_mul_f32 v34, v207, v34
    v_mul_f32 v35, v207, v35
    v_mul_f32 v36, v207, v36
    v_mul_f32 v37, v207, v37
    v_mul_f32 v38, v207, v38
    v_mul_f32 v39, v207, v39
    v_mul_f32 v40, v207, v40
    v_mul_f32 v41, v207, v41
    v_mul_f32 v42, v207, v42
    v_mul_f32 v43, v207, v43
    v_mul_f32 v44, v207, v44
    v_mul_f32 v45, v207, v45
    v_mul_f32 v46, v207, v46
    v_mul_f32 v47, v207, v47
    v_mul_f32 v48, v207, v48
    v_mul_f32 v49, v207, v49
    v_mul_f32 v50, v207, v50
    v_mul_f32 v51, v207, v51
    v_mul_f32 v52, v207, v52
    v_mul_f32 v53, v207, v53
    v_mul_f32 v54, v207, v54
    v_mul_f32 v55, v207, v55
    v_mul_f32 v56, v207, v56
    v_mul_f32 v57, v207, v57
    v_mul_f32 v58, v207, v58
    v_mul_f32 v59, v207, v59
    v_mul_f32 v60, v207, v60
    v_mul_f32 v61, v207, v61
    v_mul_f32 v62, v207, v62
    v_mul_f32 v63, v207, v63
    v_mul_f32 v64, v207, v64
    v_mul_f32 v65, v207, v65
    v_mul_f32 v66, v207, v66
    v_mul_f32 v67, v207, v67
    v_mul_f32 v68, v207, v68
    v_mul_f32 v69, v207, v69
    v_mul_f32 v70, v207, v70
    v_mul_f32 v71, v207, v71
    v_mul_f32 v72, v207, v72
    v_mul_f32 v73, v207, v73
    v_mul_f32 v74, v207, v74
    v_mul_f32 v75, v207, v75
    v_mul_f32 v76, v207, v76
    v_mul_f32 v77, v207, v77
    v_mul_f32 v78, v207, v78
    v_mul_f32 v79, v207, v79
    v_mul_f32 v80, v207, v80
    v_mul_f32 v81, v207, v81
    v_mul_f32 v82, v207, v82
    v_mul_f32 v83, v207, v83
    v_mul_f32 v84, v207, v84
    v_mul_f32 v85, v207, v85
    v_mul_f32 v86, v207, v86
    v_mul_f32 v87, v207, v87
    v_mul_f32 v88, v207, v88
    v_mul_f32 v89, v207, v89
    v_mul_f32 v90, v207, v90
    v_mul_f32 v91, v207, v91
    v_mul_f32 v92, v207, v92
    v_mul_f32 v93, v207, v93
    v_mul_f32 v94, v207, v94
    v_mul_f32 v95, v207, v95
L_norsb:
    v_fma_f32 v96, v96, s76, -v206
    v_fma_f32 v97, v97, s76, -v206
    v_fma_f32 v98, v98, s76, -v206
    v_fma_f32 v99, v99, s76, -v206
    v_exp_f32 v96, v96
    v_exp_f32 v97, v97
    v_exp_f32 v98, v98
    v_exp_f32 v99, v99
    v_add_f32 v205, v205, v96
    v_add_f32 v212, v212, v97
    v_add_f32 v205, v205, v98
    v_add_f32 v212, v212, v99
    v_cvt_pk_bf16_f32 v96, v96, v97
    v_cvt_pk_bf16_f32 v97, v98, v99
    v_fma_f32 v100, v100, s76, -v206
    v_fma_f32 v101, v101, s76, -v206
    v_fma_f32 v102, v102, s76, -v206
    v_fma_f32 v103, v103, s76, -v206
    v_exp_f32 v100, v100
    v_exp_f32 v101, v101
    v_exp_f32 v102, v102
    v_exp_f32 v103, v103
    v_add_f32 v205, v205, v100
    v_add_f32 v212, v212, v101
    v_add_f32 v205, v205, v102
    v_add_f32 v212, v212, v103
    v_cvt_pk_bf16_f32 v98, v100, v101
    v_cvt_pk_bf16_f32 v99, v102, v103
    ds_read_b64_tr_b16 v[172:173], v203 offset:4096
    ds_read_b64_tr_b16 v[174:175], v203 offset:5120
    s_waitcnt lgkmcnt(14)
    v_mfma_f32_32x32x16_bf16 v[32:47], v[16:19], v[96:99], v[32:47]
    s_add_u32 s72, s71, 16384
    s_cmp_ge_u32 s72, 81920
    s_cselect_b32 s72, 81920, 0
    s_sub_u32 s72, 16384, s72
    v_fma_f32 v104, v104, s76, -v206
    v_fma_f32 v105, v105, s76, -v206
    v_fma_f32 v106, v106, s76, -v206
    v_fma_f32 v107, v107, s76, -v206
    v_exp_f32 v104, v104
    v_exp_f32 v105, v105
    v_exp_f32 v106, v106
    ds_read_b64_tr_b16 v[16:17], v200 offset:8192
    ds_read_b64_tr_b16 v[18:19], v200 offset:9216
    s_waitcnt lgkmcnt(14)
    v_mfma_f32_32x32x16_bf16 v[48:63], v[20:23], v[96:99], v[48:63]
    v_exp_f32 v107, v107
    v_add_f32 v205, v205, v104
    v_add_f32 v212, v212, v105
    v_add_f32 v205, v205, v106
    v_add_f32 v212, v212, v107
    v_cvt_pk_bf16_f32 v100, v104, v105
    v_cvt_pk_bf16_f32 v101, v106, v107
    ds_read_b64_tr_b16 v[20:21], v201 offset:8192
    ds_read_b64_tr_b16 v[22:23], v201 offset:9216
    s_waitcnt lgkmcnt(14)
    v_mfma_f32_32x32x16_bf16 v[64:79], v[24:27], v[96:99], v[64:79]
    v_fma_f32 v108, v108, s76, -v206
    v_fma_f32 v109, v109, s76, -v206
    v_fma_f32 v110, v110, s76, -v206
    v_fma_f32 v111, v111, s76, -v206
    v_exp_f32 v108, v108
    v_exp_f32 v109, v109
    v_exp_f32 v110, v110
    ds_read_b64_tr_b16 v[24:25], v202 offset:8192
    ds_read_b64_tr_b16 v[26:27], v202 offset:9216
    s_waitcnt lgkmcnt(14)
    v_mfma_f32_32x32x16_bf16 v[80:95], v[28:31], v[96:99], v[80:95]
    v_exp_f32 v111, v111
    v_add_f32 v205, v205, v108
    v_add_f32 v212, v212, v109
    v_add_f32 v205, v205, v110
    v_add_f32 v212, v212, v111
    v_cvt_pk_bf16_f32 v102, v108, v109
    v_cvt_pk_bf16_f32 v103, v110, v111
    ds_read_b64_tr_b16 v[28:29], v203 offset:8192
    ds_read_b64_tr_b16 v[30:31], v203 offset:9216
    s_waitcnt lgkmcnt(14)
    v_mfma_f32_32x32x16_bf16 v[32:47], v[160:163], v[100:103], v[32:47]
    v_fma_f32 v112, v112, s76, -v206
    v_fma_f32 v113, v113, s76, -v206
    v_fma_f32 v114, v114, s76, -v206
    v_fma_f32 v115, v115, s76, -v206
    v_exp_f32 v112, v112
    v_exp_f32 v113, v113
    v_exp_f32 v114, v114
    ds_read_b64_tr_b16 v[160:161], v200 offset:12288
    ds_read_b64_tr_b16 v[162:163], v200 offset:13312
    v_add_u32 v200, s72, v200
    s_waitcnt lgkmcnt(14)
    v_mfma_f32_32x32x16_bf16 v[48:63], v[164:167], v[100:103], v[48:63]
    v_exp_f32 v115, v115
    v_add_f32 v205, v205, v112
    v_add_f32 v212, v212, v113
    v_add_f32 v205, v205, v114
    v_add_f32 v212, v212, v115
    v_cvt_pk_bf16_f32 v112, v112, v113
    v_cvt_pk_bf16_f32 v113, v114, v115
    ds_read_b64_tr_b16 v[164:165], v201 offset:12288
    ds_read_b64_tr_b16 v[166:167], v201 offset:13312
    v_add_u32 v201, s72, v201
    s_waitcnt lgkmcnt(14)
    v_mfma_f32_32x32x16_bf16 v[64:79], v[168:171], v[100:103], v[64:79]
    v_fma_f32 v116, v116, s76, -v206
    v_fma_f32 v117, v117, s76, -v206
    v_fma_f32 v118, v118, s76, -v206
    v_fma_f32 v119, v119, s76, -v206
    v_exp_f32 v116, v116
    v_exp_f32 v117, v117
    v_exp_f32 v118, v118
    ds_read_b64_tr_b16 v[168:169], v202 offset:12288
    ds_read_b64_tr_b16 v[170:171], v202 offset:13312
    v_add_u32 v202, s72, v202
    s_waitcnt lgkmcnt(14)
    v_mfma_f32_32x32x16_bf16 v[80:95], v[172:175], v[100:103], v[80:95]
    v_exp_f32 v119, v119
    v_add_f32 v205, v205, v116
    v_add_f32 v212, v212, v117
    v_add_f32 v205, v205, v118
    v_add_f32 v212, v212, v119
    v_cvt_pk_bf16_f32 v114, v116, v117
    v_cvt_pk_bf16_f32 v115, v118, v119
    ds_read_b64_tr_b16 v[172:173], v203 offset:12288
    ds_read_b64_tr_b16 v[174:175], v203 offset:13312
    v_add_u32 v203, s72, v203
    s_waitcnt lgkmcnt(14)
    v_mfma_f32_32x32x16_bf16 v[32:47], v[16:19], v[112:115], v[32:47]
    v_fma_f32 v120, v120, s76, -v206
    v_fma_f32 v121, v121, s76, -v206
    v_fma_f32 v122, v122, s76, -v206
    v_fma_f32 v123, v123, s76, -v206
    v_exp_f32 v120, v120
    v_exp_f32 v121, v121
    v_exp_f32 v122, v122
    ds_read_b64_tr_b16 v[16:17], v200
    ds_read_b64_tr_b16 v[18:19], v200 offset:1024
    s_waitcnt lgkmcnt(14)
    v_mfma_f32_32x32x16_bf16 v[48:63], v[20:23], v[112:115], v[48:63]
    v_exp_f32 v123, v123
    v_add_f32 v205, v205, v120
    v_add_f32 v212, v212, v121
    v_add_f32 v205, v205, v122
    v_add_f32 v212, v212, v123
    v_cvt_pk_bf16_f32 v116, v120, v121
    v_cvt_pk_bf16_f32 v117, v122, v123
    ds_read_b64_tr_b16 v[20:21], v201
    ds_read_b64_tr_b16 v[22:23], v201 offset:1024
    s_waitcnt lgkmcnt(14)
    v_mfma_f32_32x32x16_bf16 v[64:79], v[24:27], v[112:115], v[64:79]
    v_fma_f32 v124, v124, s76, -v206
    v_fma_f32 v125, v125, s76, -v206
    v_fma_f32 v126, v126, s76, -v206
    v_fma_f32 v127, v127, s76, -v206
    v_exp_f32 v124, v124
    v_exp_f32 v125, v125
    v_exp_f32 v126, v126
    ds_read_b64_tr_b16 v[24:25], v202
    ds_read_b64_tr_b16 v[26:27], v202 offset:1024
    s_waitcnt lgkmcnt(14)
    v_mfma_f32_32x32x16_bf16 v[80:95], v[28:31], v[112:115], v[80:95]
    v_exp_f32 v127, v127
    v_add_f32 v205, v205, v124
    v_add_f32 v212, v212, v125
    v_add_f32 v205, v205, v126
    v_add_f32 v212, v212, v127
    v_cvt_pk_bf16_f32 v118, v124, v125
    v_cvt_pk_bf16_f32 v119, v126, v127
    ds_read_b64_tr_b16 v[28:29], v203
    ds_read_b64_tr_b16 v[30:31], v203 offset:1024
    s_waitcnt lgkmcnt(14)
    v_mfma_f32_32x32x16_bf16 v[32:47], v[160:163], v[116:119], v[32:47]
    v_fma_f32 v128, v128, s76, -v206
    v_fma_f32 v129, v129, s76, -v206
    v_fma_f32 v130, v130, s76, -v206
    v_fma_f32 v131, v131, s76, -v206
    v_exp_f32 v128, v128
    v_exp_f32 v129, v129
    v_exp_f32 v130, v130
    ds_read_b64_tr_b16 v[160:161], v200 offset:4096
    ds_read_b64_tr_b16 v[162:163], v200 offset:5120
    s_waitcnt lgkmcnt(14)
    v_mfma_f32_32x32x16_bf16 v[48:63], v[164:167], v[116:119], v[48:63]
    v_exp_f32 v131, v131
    v_add_f32 v205, v205, v128
    v_add_f32 v212, v212, v129
    v_add_f32 v205, v205, v130
    v_add_f32 v212, v212, v131
    v_cvt_pk_bf16_f32 v128, v128, v129
    v_cvt_pk_bf16_f32 v129, v130, v131
    ds_read_b64_tr_b16 v[164:165], v201 offset:4096
    ds_read_b64_tr_b16 v[166:167], v201 offset:5120
    s_waitcnt lgkmcnt(14)
    v_mfma_f32_32x32x16_bf16 v[64:79], v[168:171], v[116:119], v[64:79]
    v_fma_f32 v132, v132, s76, -v206
    v_fma_f32 v133, v133, s76, -v206
    v_fma_f32 v134, v134, s76, -v206
    v_fma_f32 v135, v135, s76, -v206
    v_exp_f32 v132, v132
    v_exp_f32 v133, v133
    v_exp_f32 v134, v134
    ds_read_b64_tr_b16 v[168:169], v202 offset:4096
    ds_read_b64_tr_b16 v[170:171], v202 offset:5120
    s_waitcnt lgkmcnt(14)
    v_mfma_f32_32x32x16_bf16 v[80:95], v[172:175], v[116:119], v[80:95]
    v_exp_f32 v135, v135
    v_add_f32 v205, v205, v132
    v_add_f32 v212, v212, v133
    v_add_f32 v205, v205, v134
    v_add_f32 v212, v212, v135
    v_cvt_pk_bf16_f32 v130, v132, v133
    v_cvt_pk_bf16_f32 v131, v134, v135
    s_add_u32 s71, s71, 16384
    s_cmp_eq_u32 s71, 81920
    s_cselect_b32 s71, 0, s71
    ds_read_b64_tr_b16 v[172:173], v203 offset:4096
    ds_read_b64_tr_b16 v[174:175], v203 offset:5120
    s_waitcnt lgkmcnt(14)
    v_mfma_f32_32x32x16_bf16 v[32:47], v[16:19], v[128:131], v[32:47]
    s_add_u32 s72, s71, 49152
    s_cmp_ge_u32 s72, 81920
    s_cselect_b32 s72, 81920, 0
    s_sub_u32 s72, 49152, s72
    v_fma_f32 v136, v136, s76, -v206
    v_fma_f32 v137, v137, s76, -v206
    v_fma_f32 v138, v138, s76, -v206
    v_fma_f32 v139, v139, s76, -v206
    v_exp_f32 v136, v136
    v_exp_f32 v137, v137
    v_exp_f32 v138, v138
    ds_read_b64_tr_b16 v[16:17], v200 offset:8192
    ds_read_b64_tr_b16 v[18:19], v200 offset:9216
    s_waitcnt lgkmcnt(14)
    v_mfma_f32_32x32x16_bf16 v[48:63], v[20:23], v[128:131], v[48:63]
    v_exp_f32 v139, v139
    v_add_f32 v205, v205, v136
    v_add_f32 v212, v212, v137
    v_add_f32 v205, v205, v138
    v_add_f32 v212, v212, v139
    v_cvt_pk_bf16_f32 v132, v136, v137
    v_cvt_pk_bf16_f32 v133, v138, v139
    ds_read_b64_tr_b16 v[20:21], v201 offset:8192
    ds_read_b64_tr_b16 v[22:23], v201 offset:9216
    s_waitcnt lgkmcnt(14)
    v_mfma_f32_32x32x16_bf16 v[64:79], v[24:27], v[128:131], v[64:79]
    v_fma_f32 v140, v140, s76, -v206
    v_fma_f32 v141, v141, s76, -v206
    v_fma_f32 v142, v142, s76, -v206
    v_fma_f32 v143, v143, s76, -v206
    v_exp_f32 v140, v140
    v_exp_f32 v141, v141
    v_exp_f32 v142, v142
    ds_read_b64_tr_b16 v[24:25], v202 offset:8192
    ds_read_b64_tr_b16 v[26:27], v202 offset:9216
    s_waitcnt lgkmcnt(14)
    v_mfma_f32_32x32x16_bf16 v[80:95], v[28:31], v[128:131], v[80:95]
    v_exp_f32 v143, v143
    v_add_f32 v205, v205, v140
    v_add_f32 v212, v212, v141
    v_add_f32 v205, v205, v142
    v_add_f32 v212, v212, v143
    v_cvt_pk_bf16_f32 v134, v140, v141
    v_cvt_pk_bf16_f32 v135, v142, v143
    ds_read_b64_tr_b16 v[28:29], v203 offset:8192
    ds_read_b64_tr_b16 v[30:31], v203 offset:9216
    s_waitcnt lgkmcnt(14)
    v_mfma_f32_32x32x16_bf16 v[32:47], v[160:163], v[132:135], v[32:47]
    v_fma_f32 v144, v144, s76, -v206
    v_fma_f32 v145, v145, s76, -v206
    v_fma_f32 v146, v146, s76, -v206
    v_fma_f32 v147, v147, s76, -v206
    v_exp_f32 v144, v144
    v_exp_f32 v145, v145
    v_exp_f32 v146, v146
    ds_read_b64_tr_b16 v[160:161], v200 offset:12288
    ds_read_b64_tr_b16 v[162:163], v200 offset:13312
    v_add_u32 v200, s72, v200
    s_waitcnt lgkmcnt(14)
    v_mfma_f32_32x32x16_bf16 v[48:63], v[164:167], v[132:135], v[48:63]
    v_exp_f32 v147, v147
    v_add_f32 v205, v205, v144
    v_add_f32 v212, v212, v145
    v_add_f32 v205, v205, v146
    v_add_f32 v212, v212, v147
    v_cvt_pk_bf16_f32 v144, v144, v145
    v_cvt_pk_bf16_f32 v145, v146, v147
    ds_read_b64_tr_b16 v[164:165], v201 offset:12288
    ds_read_b64_tr_b16 v[166:167], v201 offset:13312
    v_add_u32 v201, s72, v201
    s_waitcnt lgkmcnt(14)
    v_mfma_f32_32x32x16_bf16 v[64:79], v[168:171], v[132:135], v[64:79]
    v_fma_f32 v148, v148, s76, -v206
    v_fma_f32 v149, v149, s76, -v206
    v_fma_f32 v150, v150, s76, -v206
    v_fma_f32 v151, v151, s76, -v206
    v_exp_f32 v148, v148
    v_exp_f32 v149, v149
    v_exp_f32 v150, v150
    ds_read_b64_tr_b16 v[168:169], v202 offset:12288
    ds_read_b64_tr_b16 v[170:171], v202 offset:13312
    v_add_u32 v202, s72, v202
    s_waitcnt lgkmcnt(14)
    v_mfma_f32_32x32x16_bf16 v[80:95], v[172:175], v[132:135], v[80:95]
    v_exp_f32 v151, v151
    v_add_f32 v205, v205, v148
    v_add_f32 v212, v212, v149
    v_add_f32 v205, v205, v150
    v_add_f32 v212, v212, v151
    v_cvt_pk_bf16_f32 v146, v148, v149
    v_cvt_pk_bf16_f32 v147, v150, v151
    ds_read_b64_tr_b16 v[172:173], v203 offset:12288
    ds_read_b64_tr_b16 v[174:175], v203 offset:13312
    v_add_u32 v203, s72, v203
    s_waitcnt lgkmcnt(14)
    v_mfma_f32_32x32x16_bf16 v[32:47], v[16:19], v[144:147], v[32:47]
    v_fma_f32 v152, v152, s76, -v206
    v_fma_f32 v153, v153, s76, -v206
    v_fma_f32 v154, v154, s76, -v206
    v_fma_f32 v155, v155, s76, -v206
    v_exp_f32 v152, v152
    v_exp_f32 v153, v153
    v_exp_f32 v154, v154
    s_waitcnt lgkmcnt(12)
    v_mfma_f32_32x32x16_bf16 v[48:63], v[20:23], v[144:147], v[48:63]
    v_exp_f32 v155, v155
    v_add_f32 v205, v205, v152
    v_add_f32 v212, v212, v153
    v_add_f32 v205, v205, v154
    v_add_f32 v212, v212, v155
    v_cvt_pk_bf16_f32 v148, v152, v153
    v_cvt_pk_bf16_f32 v149, v154, v155
    s_waitcnt lgkmcnt(10)
    v_mfma_f32_32x32x16_bf16 v[64:79], v[24:27], v[144:147], v[64:79]
    v_fma_f32 v156, v156, s76, -v206
    v_fma_f32 v157, v157, s76, -v206
    v_fma_f32 v158, v158, s76, -v206
    v_fma_f32 v159, v159, s76, -v206
    v_exp_f32 v156, v156
    v_exp_f32 v157, v157
    v_exp_f32 v158, v158
    s_waitcnt lgkmcnt(8)
    v_mfma_f32_32x32x16_bf16 v[80:95], v[28:31], v[144:147], v[80:95]
    v_exp_f32 v159, v159
    v_add_f32 v205, v205, v156
    v_add_f32 v212, v212, v157
    v_add_f32 v205, v205, v158
    v_add_f32 v212, v212, v159
    v_cvt_pk_bf16_f32 v150, v156, v157
    v_cvt_pk_bf16_f32 v151, v158, v159
    s_waitcnt lgkmcnt(6)
    s_nop 0
    v_mfma_f32_32x32x16_bf16 v[32:47], v[160:163], v[148:151], v[32:47]
    s_waitcnt lgkmcnt(4)
    v_mfma_f32_32x32x16_bf16 v[48:63], v[164:167], v[148:151], v[48:63]
    s_waitcnt lgkmcnt(2)
    v_mfma_f32_32x32x16_bf16 v[64:79], v[168:171], v[148:151], v[64:79]
    s_waitcnt lgkmcnt(0)
    v_mfma_f32_32x32x16_bf16 v[80:95], v[172:175], v[148:151], v[80:95]
    s_add_u32 s71, s71, 16384
    s_cmp_eq_u32 s71, 81920
    s_cselect_b32 s71, 0, s71
    v_add_f32 v205, v205, v212
    v_mov_b32 v209, v205
    s_nop 1
    v_permlane32_swap_b32 v205, v209
    v_add_f32 v205, v205, v209
    v_rcp_f32 v207, v205
    v_bfe_u32 v208, v1, 4, 1
    v_lshlrev_b32 v208, 17, v208
    v_lshrrev_b32 v209, 5, v1
    v_lshl_add_u32 v208, v209, 8, v208
    v_and_b32 v209, 15, v1
    v_lshl_add_u32 v208, v209, 4, v208
    s_lshl_b32 s9, s6, 6
    s_lshl_b32 s10, s8, 3
    s_add_u32 s9, s9, s10
    s_lshl_b32 s10, s5, 1
    s_add_u32 s9, s9, s10
    s_lshl_b32 s9, s9, 7
    s_lshl_b32 s10, s7, 2
    s_add_u32 s9, s9, s10
    s_lshl_b32 s9, s9, 10
    v_mul_f32 v32, v207, v32
    v_mul_f32 v33, v207, v33
    v_mul_f32 v34, v207, v34
    v_mul_f32 v35, v207, v35
    v_mul_f32 v36, v207, v36
    v_mul_f32 v37, v207, v37
    v_mul_f32 v38, v207, v38
    v_mul_f32 v39, v207, v39
    v_mul_f32 v40, v207, v40
    v_mul_f32 v41, v207, v41
    v_mul_f32 v42, v207, v42
    v_mul_f32 v43, v207, v43
    v_mul_f32 v44, v207, v44
    v_mul_f32 v45, v207, v45
    v_mul_f32 v46, v207, v46
    v_mul_f32 v47, v207, v47
    v_cvt_pk_bf16_f32 v96, v32, v33
    v_cvt_pk_bf16_f32 v97, v34, v35
    v_cvt_pk_bf16_f32 v98, v36, v37
    v_cvt_pk_bf16_f32 v99, v38, v39
    v_cvt_pk_bf16_f32 v100, v40, v41
    v_cvt_pk_bf16_f32 v101, v42, v43
    v_cvt_pk_bf16_f32 v102, v44, v45
    v_cvt_pk_bf16_f32 v103, v46, v47
    buffer_store_dwordx4 v[96:99], v208, s[40:43], s9 offen sc1
    buffer_store_dwordx4 v[100:103], v208, s[40:43], s9 offen offset:512 sc1
    v_mul_f32 v48, v207, v48
    v_mul_f32 v49, v207, v49
    v_mul_f32 v50, v207, v50
    v_mul_f32 v51, v207, v51
    v_mul_f32 v52, v207, v52
    v_mul_f32 v53, v207, v53
    v_mul_f32 v54, v207, v54
    v_mul_f32 v55, v207, v55
    v_mul_f32 v56, v207, v56
    v_mul_f32 v57, v207, v57
    v_mul_f32 v58, v207, v58
    v_mul_f32 v59, v207, v59
    v_mul_f32 v60, v207, v60
    v_mul_f32 v61, v207, v61
    v_mul_f32 v62, v207, v62
    v_mul_f32 v63, v207, v63
    v_cvt_pk_bf16_f32 v104, v48, v49
    v_cvt_pk_bf16_f32 v105, v50, v51
    v_cvt_pk_bf16_f32 v106, v52, v53
    v_cvt_pk_bf16_f32 v107, v54, v55
    v_cvt_pk_bf16_f32 v108, v56, v57
    v_cvt_pk_bf16_f32 v109, v58, v59
    v_cvt_pk_bf16_f32 v110, v60, v61
    v_cvt_pk_bf16_f32 v111, v62, v63
    buffer_store_dwordx4 v[104:107], v208, s[40:43], s9 offen offset:1024 sc1
    buffer_store_dwordx4 v[108:111], v208, s[40:43], s9 offen offset:1536 sc1
    v_mul_f32 v64, v207, v64
    v_mul_f32 v65, v207, v65
    v_mul_f32 v66, v207, v66
    v_mul_f32 v67, v207, v67
    v_mul_f32 v68, v207, v68
    v_mul_f32 v69, v207, v69
    v_mul_f32 v70, v207, v70
    v_mul_f32 v71, v207, v71
    v_mul_f32 v72, v207, v72
    v_mul_f32 v73, v207, v73
    v_mul_f32 v74, v207, v74
    v_mul_f32 v75, v207, v75
    v_mul_f32 v76, v207, v76
    v_mul_f32 v77, v207, v77
    v_mul_f32 v78, v207, v78
    v_mul_f32 v79, v207, v79
    v_cvt_pk_bf16_f32 v112, v64, v65
    v_cvt_pk_bf16_f32 v113, v66, v67
    v_cvt_pk_bf16_f32 v114, v68, v69
    v_cvt_pk_bf16_f32 v115, v70, v71
    v_cvt_pk_bf16_f32 v116, v72, v73
    v_cvt_pk_bf16_f32 v117, v74, v75
    v_cvt_pk_bf16_f32 v118, v76, v77
    v_cvt_pk_bf16_f32 v119, v78, v79
    buffer_store_dwordx4 v[112:115], v208, s[40:43], s9 offen offset:2048 sc1
    buffer_store_dwordx4 v[116:119], v208, s[40:43], s9 offen offset:2560 sc1
    v_mul_f32 v80, v207, v80
    v_mul_f32 v81, v207, v81
    v_mul_f32 v82, v207, v82
    v_mul_f32 v83, v207, v83
    v_mul_f32 v84, v207, v84
    v_mul_f32 v85, v207, v85
    v_mul_f32 v86, v207, v86
    v_mul_f32 v87, v207, v87
    v_mul_f32 v88, v207, v88
    v_mul_f32 v89, v207, v89
    v_mul_f32 v90, v207, v90
    v_mul_f32 v91, v207, v91
    v_mul_f32 v92, v207, v92
    v_mul_f32 v93, v207, v93
    v_mul_f32 v94, v207, v94
    v_mul_f32 v95, v207, v95
    v_cvt_pk_bf16_f32 v120, v80, v81
    v_cvt_pk_bf16_f32 v121, v82, v83
    v_cvt_pk_bf16_f32 v122, v84, v85
    v_cvt_pk_bf16_f32 v123, v86, v87
    v_cvt_pk_bf16_f32 v124, v88, v89
    v_cvt_pk_bf16_f32 v125, v90, v91
    v_cvt_pk_bf16_f32 v126, v92, v93
    v_cvt_pk_bf16_f32 v127, v94, v95
    buffer_store_dwordx4 v[120:123], v208, s[40:43], s9 offen offset:3072 sc1
    buffer_store_dwordx4 v[124:127], v208, s[40:43], s9 offen offset:3584 sc1
    s_waitcnt vmcnt(0)
    s_barrier
    s_load_dwordx2 s[20:21], s[0:1], 96
    s_load_dwordx2 s[36:37], s[0:1], 32
    s_load_dwordx2 s[38:39], s[0:1], 72
    s_load_dwordx2 s[40:41], s[0:1], 88
    s_and_b32 s8, s2, 7
    s_lshr_b32 s4, s8, 2
    s_and_b32 s5, s8, 3
    s_lshr_b32 s9, s2, 3
    s_and_b32 s7, s9, 3
    s_lshr_b32 s6, s9, 2
    v_lshlrev_b32 v2, 4, v1
    s_waitcnt lgkmcnt(0)
    s_mov_b32 s12, s20
    s_mov_b32 s13, s21
    s_mov_b32 s14, 67108864
    s_mov_b32 s15, 0x00020000
    s_cmp_eq_u32 s4, 0
    s_cselect_b64 s[36:37], s[36:37], s[38:39]
    s_mov_b32 s16, s36
    s_mov_b32 s17, s37
    s_mov_b32 s18, 5242880
    s_mov_b32 s19, 0x00020000
    s_mov_b32 s44, s40
    s_mov_b32 s45, s41
    s_mov_b32 s46, 256
    s_mov_b32 s47, 0x00020000
    s_cmp_lt_u32 s3, 4
    s_cbranch_scc1 L_op_compute
    s_and_b32 s8, s2, 7
    s_lshl_b32 s8, s8, 2
    s_lshr_b32 s9, s2, 6
    s_add_u32 s8, s8, s9
    s_lshl_b32 s34, s8, 3
    s_lshr_b32 s50, s2, 3
    s_and_b32 s50, s50, 7
    s_lshl_b32 s51, 1, s50
    v_mov_b32 v20, s51
    v_mov_b32 v21, 0
    s_cmp_lg_u32 s3, 4
    s_cbranch_scc1 L_op_noadd
    s_mov_b64 s[48:49], exec
    s_mov_b64 exec, 1
    buffer_atomic_or v20, v21, s[44:47], s34 offen
    s_mov_b64 exec, s[48:49]
L_op_noadd:
    s_sub_u32 s31, s3, 4
    s_lshl_b32 s30, s31, 11
    s_mul_i32 s32, s31, 5120
    s_lshl_b32 s10, s5, 15
    s_lshl_b32 s8, s4, 6
    s_lshl_b32 s9, s6, 3
    s_add_u32 s8, s8, s9
    s_add_u32 s8, s8, s31
    s_lshl_b32 s8, s8, 17
    s_add_u32 s24, s8, s10
    s_add_u32 s25, s24, 524288
    s_lshl_b32 s8, s5, 10
    s_lshl_b32 s9, s31, 4
    s_add_u32 s8, s8, s9
    s_mul_i32 s8, s8, 1280
    s_mul_i32 s9, s7, 320
    s_add_u32 s26, s8, s9
    s_lshl_b32 s8, s50, 12
    s_add_u32 s24, s24, s8
    s_add_u32 s25, s25, s8
    s_mul_i32 s8, s50, 163840
    s_add_u32 s26, s26, s8
    s_lshl_b32 s52, s50, 1
    s_add_u32 s8, s30, 0
    s_mov_b32 m0, s8
    s_nop 0
    buffer_load_dwordx4 v2, s[12:15], s24 offen sc1 lds
    buffer_load_dwordx4 v2, s[12:15], s24 offen offset:1024 sc1 lds
    s_add_u32 s24, s24, 2048
    s_add_u32 s8, s30, 8192
    s_mov_b32 m0, s8
    s_nop 0
    buffer_load_dwordx4 v2, s[12:15], s25 offen sc1 lds
    buffer_load_dwordx4 v2, s[12:15], s25 offen offset:1024 sc1 lds
    s_add_u32 s25, s25, 2048
    s_add_u32 s8, s30, 36864
    s_mov_b32 m0, s8
    s_nop 0
    buffer_load_dwordx4 v2, s[12:15], s24 offen sc1 lds
    buffer_load_dwordx4 v2, s[12:15], s24 offen offset:1024 sc1 lds
    s_add_u32 s24, s24, 2048
    s_add_u32 s8, s30, 45056
    s_mov_b32 m0, s8
    s_nop 0
    buffer_load_dwordx4 v2, s[12:15], s25 offen sc1 lds
    buffer_load_dwordx4 v2, s[12:15], s25 offen offset:1024 sc1 lds
    s_add_u32 s25, s25, 2048
    s_mov_b32 s8, 3277
    v_add_u32 v16, 0, v1
    v_mul_lo_u32 v17, v16, s8
    v_lshrrev_b32 v17, 16, v17
    v_mul_u32_u24 v18, 20, v17
    v_sub_u32 v18, v16, v18
    v_bfe_u32 v19, v17, 3, 1
    v_lshlrev_b32 v19, 1, v19
    v_sub_u32 v18, v18, v19
    v_add_u32 v19, 20, v18
    v_cmp_gt_i32 vcc, 0, v18
    s_nop 1
    v_cndmask_b32 v18, v18, v19, vcc
    v_mul_u32_u24 v17, 1280, v17
    v_lshl_add_u32 v17, v18, 4, v17
    v_mov_b32 v8, v17
    v_add_u32 v16, 64, v1
    v_mul_lo_u32 v17, v16, s8
    v_lshrrev_b32 v17, 16, v17
    v_mul_u32_u24 v18, 20, v17
    v_sub_u32 v18, v16, v18
    v_bfe_u32 v19, v17, 3, 1
    v_lshlrev_b32 v19, 1, v19
    v_sub_u32 v18, v18, v19
    v_add_u32 v19, 20, v18
    v_cmp_gt_i32 vcc, 0, v18
    s_nop 1
    v_cndmask_b32 v18, v18, v19, vcc
    v_mul_u32_u24 v17, 1280, v17
    v_lshl_add_u32 v17, v18, 4, v17
    v_subrev_u32 v9, 1024, v17
    v_add_u32 v16, 128, v1
    v_mul_lo_u32 v17, v16, s8
    v_lshrrev_b32 v17, 16, v17
    v_mul_u32_u24 v18, 20, v17
    v_sub_u32 v18, v16, v18
    v_bfe_u32 v19, v17, 3, 1
    v_lshlrev_b32 v19, 1, v19
    v_sub_u32 v18, v18, v19
    v_add_u32 v19, 20, v18
    v_cmp_gt_i32 vcc, 0, v18
    s_nop 1
    v_cndmask_b32 v18, v18, v19, vcc
    v_mul_u32_u24 v17, 1280, v17
    v_lshl_add_u32 v17, v18, 4, v17
    v_subrev_u32 v10, 2048, v17
    v_add_u32 v16, 192, v1
    v_mul_lo_u32 v17, v16, s8
    v_lshrrev_b32 v17, 16, v17
    v_mul_u32_u24 v18, 20, v17
    v_sub_u32 v18, v16, v18
    v_bfe_u32 v19, v17, 3, 1
    v_lshlrev_b32 v19, 1, v19
    v_sub_u32 v18, v18, v19
    v_add_u32 v19, 20, v18
    v_cmp_gt_i32 vcc, 0, v18
    s_nop 1
    v_cndmask_b32 v18, v18, v19, vcc
    v_mul_u32_u24 v17, 1280, v17
    v_lshl_add_u32 v17, v18, 4, v17
    v_subrev_u32 v11, 3072, v17
    v_add_u32 v16, 256, v1
    v_mul_lo_u32 v17, v16, s8
    v_lshrrev_b32 v17, 16, v17
    v_mul_u32_u24 v18, 20, v17
    v_sub_u32 v18, v16, v18
    v_bfe_u32 v19, v17, 3, 1
    v_lshlrev_b32 v19, 1, v19
    v_sub_u32 v18, v18, v19
    v_add_u32 v19, 20, v18
    v_cmp_gt_i32 vcc, 0, v18
    s_nop 1
    v_cndmask_b32 v18, v18, v19, vcc
    v_mul_u32_u24 v17, 1280, v17
    v_lshl_add_u32 v17, v18, 4, v17
    v_mov_b32 v12, v17
    s_add_u32 s8, s32, 16384
    s_mov_b32 m0, s8
    s_nop 0
    buffer_load_dwordx4 v8, s[16:19], s26 offen lds
    buffer_load_dwordx4 v9, s[16:19], s26 offen offset:1024 lds
    buffer_load_dwordx4 v10, s[16:19], s26 offen offset:2048 lds
    buffer_load_dwordx4 v11, s[16:19], s26 offen offset:3072 lds
    s_add_u32 s8, s8, 4096
    s_mov_b32 m0, s8
    s_nop 0
    buffer_load_dwordx4 v12, s[16:19], s26 offen lds
    s_add_u32 s26, s26, 81920
    s_add_u32 s8, s32, 53248
    s_mov_b32 m0, s8
    s_nop 0
    buffer_load_dwordx4 v8, s[16:19], s26 offen lds
    buffer_load_dwordx4 v9, s[16:19], s26 offen offset:1024 lds
    buffer_load_dwordx4 v10, s[16:19], s26 offen offset:2048 lds
    buffer_load_dwordx4 v11, s[16:19], s26 offen offset:3072 lds
    s_add_u32 s8, s8, 4096
    s_mov_b32 m0, s8
    s_nop 0
    buffer_load_dwordx4 v12, s[16:19], s26 offen lds
    s_add_u32 s26, s26, 81920
    s_add_u32 s52, s52, 2
    s_cmp_eq_u32 s52, 16
    s_cselect_b32 s8, 32768, 0
    s_cselect_b32 s9, 1310720, 0
    s_sub_u32 s24, s24, s8
    s_sub_u32 s25, s25, s8
    s_sub_u32 s26, s26, s9
    s_cmp_lg_u32 s3, 4
    s_cbranch_scc1 L_op_ck1
    s_add_u32 s10, s50, 1
    s_and_b32 s10, s10, 7
    s_lshl_b32 s10, 1, s10
    s_mov_b32 s53, 0
L_op_pl1:
    s_and_b32 s8, s51, s10
    s_cbranch_scc1 L_op_ck1
    buffer_load_dword v22, v21, s[44:47], s34 offen sc1
    s_waitcnt vmcnt(0)
    v_readfirstlane_b32 s51, v22
    s_add_u32 s53, s53, 1
    s_cmp_lt_u32 s53, 2097152
    s_cbranch_scc1 L_op_pl1
L_op_ck1:
    s_waitcnt vmcnt(0)
    s_barrier
    s_add_u32 s8, s30, 73728
    s_mov_b32 m0, s8
    s_nop 0
    buffer_load_dwordx4 v2, s[12:15], s24 offen sc1 lds
    buffer_load_dwordx4 v2, s[12:15], s24 offen offset:1024 sc1 lds
    s_add_u32 s24, s24, 2048
    s_add_u32 s8, s30, 81920
    s_mov_b32 m0, s8
    s_nop 0
    buffer_load_dwordx4 v2, s[12:15], s25 offen sc1 lds
    buffer_load_dwordx4 v2, s[12:15], s25 offen offset:1024 sc1 lds
    s_add_u32 s25, s25, 2048
    s_add_u32 s8, s32, 90112
    s_mov_b32 m0, s8
    s_nop 0
    buffer_load_dwordx4 v8, s[16:19], s26 offen lds
    buffer_load_dwordx4 v9, s[16:19], s26 offen offset:1024 lds
    buffer_load_dwordx4 v10, s[16:19], s26 offen offset:2048 lds
    buffer_load_dwordx4 v11, s[16:19], s26 offen offset:3072 lds
    s_add_u32 s8, s8, 4096
    s_mov_b32 m0, s8
    s_nop 0
    buffer_load_dwordx4 v12, s[16:19], s26 offen lds
    s_add_u32 s26, s26, 81920
    s_add_u32 s8, s30, 110592
    s_mov_b32 m0, s8
    s_nop 0
    buffer_load_dwordx4 v2, s[12:15], s24 offen sc1 lds
    buffer_load_dwordx4 v2, s[12:15], s24 offen offset:1024 sc1 lds
    s_add_u32 s24, s24, 2048
    s_add_u32 s8, s30, 118784
    s_mov_b32 m0, s8
    s_nop 0
    buffer_load_dwordx4 v2, s[12:15], s25 offen sc1 lds
    buffer_load_dwordx4 v2, s[12:15], s25 offen offset:1024 sc1 lds
    s_add_u32 s25, s25, 2048
    s_add_u32 s8, s32, 126976
    s_mov_b32 m0, s8
    s_nop 0
    buffer_load_dwordx4 v8, s[16:19], s26 offen lds
    buffer_load_dwordx4 v9, s[16:19], s26 offen offset:1024 lds
    buffer_load_dwordx4 v10, s[16:19], s26 offen offset:2048 lds
    buffer_load_dwordx4 v11, s[16:19], s26 offen offset:3072 lds
    s_add_u32 s8, s8, 4096
    s_mov_b32 m0, s8
    s_nop 0
    buffer_load_dwordx4 v12, s[16:19], s26 offen lds
    s_add_u32 s26, s26, 81920
    s_add_u32 s52, s52, 2
    s_cmp_eq_u32 s52, 16
    s_cselect_b32 s8, 32768, 0
    s_cselect_b32 s9, 1310720, 0
    s_sub_u32 s24, s24, s8
    s_sub_u32 s25, s25, s8
    s_sub_u32 s26, s26, s9
    s_cmp_lg_u32 s3, 4
    s_cbranch_scc1 L_op_ck2
    s_add_u32 s10, s50, 2
    s_and_b32 s10, s10, 7
    s_lshl_b32 s10, 1, s10
    s_mov_b32 s53, 0
L_op_pl2:
    s_and_b32 s8, s51, s10
    s_cbranch_scc1 L_op_ck2
    buffer_load_dword v22, v21, s[44:47], s34 offen sc1
    s_waitcnt vmcnt(0)
    v_readfirstlane_b32 s51, v22
    s_add_u32 s53, s53, 1
    s_cmp_lt_u32 s53, 2097152
    s_cbranch_scc1 L_op_pl2
L_op_ck2:
    s_waitcnt vmcnt(9)
    s_barrier
    s_add_u32 s8, s30, 0
    s_mov_b32 m0, s8
    s_nop 0
    buffer_load_dwordx4 v2, s[12:15], s24 offen sc1 lds
    buffer_load_dwordx4 v2, s[12:15], s24 offen offset:1024 sc1 lds
    s_add_u32 s24, s24, 2048
    s_add_u32 s8, s30, 8192
    s_mov_b32 m0, s8
    s_nop 0
    buffer_load_dwordx4 v2, s[12:15], s25 offen sc1 lds
    buffer_load_dwordx4 v2, s[12:15], s25 offen offset:1024 sc1 lds
    s_add_u32 s25, s25, 2048
    s_add_u32 s8, s32, 16384
    s_mov_b32 m0, s8
    s_nop 0
    buffer_load_dwordx4 v8, s[16:19], s26 offen lds
    buffer_load_dwordx4 v9, s[16:19], s26 offen offset:1024 lds
    buffer_load_dwordx4 v10, s[16:19], s26 offen offset:2048 lds
    buffer_load_dwordx4 v11, s[16:19], s26 offen offset:3072 lds
    s_add_u32 s8, s8, 4096
    s_mov_b32 m0, s8
    s_nop 0
    buffer_load_dwordx4 v12, s[16:19], s26 offen lds
    s_add_u32 s26, s26, 81920
    s_waitcnt vmcnt(9)
    s_barrier
    s_add_u32 s8, s30, 36864
    s_mov_b32 m0, s8
    s_nop 0
    buffer_load_dwordx4 v2, s[12:15], s24 offen sc1 lds
    buffer_load_dwordx4 v2, s[12:15], s24 offen offset:1024 sc1 lds
    s_add_u32 s24, s24, 2048
    s_add_u32 s8, s30, 45056
    s_mov_b32 m0, s8
    s_nop 0
    buffer_load_dwordx4 v2, s[12:15], s25 offen sc1 lds
    buffer_load_dwordx4 v2, s[12:15], s25 offen offset:1024 sc1 lds
    s_add_u32 s25, s25, 2048
    s_add_u32 s8, s32, 53248
    s_mov_b32 m0, s8
    s_nop 0
    buffer_load_dwordx4 v8, s[16:19], s26 offen lds
    buffer_load_dwordx4 v9, s[16:19], s26 offen offset:1024 lds
    buffer_load_dwordx4 v10, s[16:19], s26 offen offset:2048 lds
    buffer_load_dwordx4 v11, s[16:19], s26 offen offset:3072 lds
    s_add_u32 s8, s8, 4096
    s_mov_b32 m0, s8
    s_nop 0
    buffer_load_dwordx4 v12, s[16:19], s26 offen lds
    s_add_u32 s26, s26, 81920
    s_add_u32 s52, s52, 2
    s_cmp_eq_u32 s52, 16
    s_cselect_b32 s8, 32768, 0
    s_cselect_b32 s9, 1310720, 0
    s_sub_u32 s24, s24, s8
    s_sub_u32 s25, s25, s8
    s_sub_u32 s26, s26, s9
    s_cmp_lg_u32 s3, 4
    s_cbranch_scc1 L_op_ck3
    s_add_u32 s10, s50, 3
    s_and_b32 s10, s10, 7
    s_lshl_b32 s10, 1, s10
    s_mov_b32 s53, 0
L_op_pl3:
    s_and_b32 s8, s51, s10
    s_cbranch_scc1 L_op_ck3
    buffer_load_dword v22, v21, s[44:47], s34 offen sc1
    s_waitcnt vmcnt(0)
    v_readfirstlane_b32 s51, v22
    s_add_u32 s53, s53, 1
    s_cmp_lt_u32 s53, 2097152
    s_cbranch_scc1 L_op_pl3
L_op_ck3:
    s_waitcnt vmcnt(9)
    s_barrier
    s_add_u32 s8, s30, 73728
    s_mov_b32 m0, s8
    s_nop 0
    buffer_load_dwordx4 v2, s[12:15], s24 offen sc1 lds
    buffer_load_dwordx4 v2, s[12:15], s24 offen offset:1024 sc1 lds
    s_add_u32 s24, s24, 2048
    s_add_u32 s8, s30, 81920
    s_mov_b32 m0, s8
    s_nop 0
    buffer_load_dwordx4 v2, s[12:15], s25 offen sc1 lds
    buffer_load_dwordx4 v2, s[12:15], s25 offen offset:1024 sc1 lds
    s_add_u32 s25, s25, 2048
    s_add_u32 s8, s32, 90112
    s_mov_b32 m0, s8
    s_nop 0
    buffer_load_dwordx4 v8, s[16:19], s26 offen lds
    buffer_load_dwordx4 v9, s[16:19], s26 offen offset:1024 lds
    buffer_load_dwordx4 v10, s[16:19], s26 offen offset:2048 lds
    buffer_load_dwordx4 v11, s[16:19], s26 offen offset:3072 lds
    s_add_u32 s8, s8, 4096
    s_mov_b32 m0, s8
    s_nop 0
    buffer_load_dwordx4 v12, s[16:19], s26 offen lds
    s_add_u32 s26, s26, 81920
    s_waitcnt vmcnt(9)
    s_barrier
    s_add_u32 s8, s30, 110592
    s_mov_b32 m0, s8
    s_nop 0
    buffer_load_dwordx4 v2, s[12:15], s24 offen sc1 lds
    buffer_load_dwordx4 v2, s[12:15], s24 offen offset:1024 sc1 lds
    s_add_u32 s24, s24, 2048
    s_add_u32 s8, s30, 118784
    s_mov_b32 m0, s8
    s_nop 0
    buffer_load_dwordx4 v2, s[12:15], s25 offen sc1 lds
    buffer_load_dwordx4 v2, s[12:15], s25 offen offset:1024 sc1 lds
    s_add_u32 s25, s25, 2048
    s_add_u32 s8, s32, 126976
    s_mov_b32 m0, s8
    s_nop 0
    buffer_load_dwordx4 v8, s[16:19], s26 offen lds
    buffer_load_dwordx4 v9, s[16:19], s26 offen offset:1024 lds
    buffer_load_dwordx4 v10, s[16:19], s26 offen offset:2048 lds
    buffer_load_dwordx4 v11, s[16:19], s26 offen offset:3072 lds
    s_add_u32 s8, s8, 4096
    s_mov_b32 m0, s8
    s_nop 0
    buffer_load_dwordx4 v12, s[16:19], s26 offen lds
    s_add_u32 s26, s26, 81920
    s_add_u32 s52, s52, 2
    s_cmp_eq_u32 s52, 16
    s_cselect_b32 s8, 32768, 0
    s_cselect_b32 s9, 1310720, 0
    s_sub_u32 s24, s24, s8
    s_sub_u32 s25, s25, s8
    s_sub_u32 s26, s26, s9
    s_cmp_lg_u32 s3, 4
    s_cbranch_scc1 L_op_ck4
    s_add_u32 s10, s50, 4
    s_and_b32 s10, s10, 7
    s_lshl_b32 s10, 1, s10
    s_mov_b32 s53, 0
L_op_pl4:
    s_and_b32 s8, s51, s10
    s_cbranch_scc1 L_op_ck4
    buffer_load_dword v22, v21, s[44:47], s34 offen sc1
    s_waitcnt vmcnt(0)
    v_readfirstlane_b32 s51, v22
    s_add_u32 s53, s53, 1
    s_cmp_lt_u32 s53, 2097152
    s_cbranch_scc1 L_op_pl4
L_op_ck4:
    s_waitcnt vmcnt(9)
    s_barrier
    s_add_u32 s8, s30, 0
    s_mov_b32 m0, s8
    s_nop 0
    buffer_load_dwordx4 v2, s[12:15], s24 offen sc1 lds
    buffer_load_dwordx4 v2, s[12:15], s24 offen offset:1024 sc1 lds
    s_add_u32 s24, s24, 2048
    s_add_u32 s8, s30, 8192
    s_mov_b32 m0, s8
    s_nop 0
    buffer_load_dwordx4 v2, s[12:15], s25 offen sc1 lds
    buffer_load_dwordx4 v2, s[12:15], s25 offen offset:1024 sc1 lds
    s_add_u32 s25, s25, 2048
    s_add_u32 s8, s32, 16384
    s_mov_b32 m0, s8
    s_nop 0
    buffer_load_dwordx4 v8, s[16:19], s26 offen lds
    buffer_load_dwordx4 v9, s[16:19], s26 offen offset:1024 lds
    buffer_load_dwordx4 v10, s[16:19], s26 offen offset:2048 lds
    buffer_load_dwordx4 v11, s[16:19], s26 offen offset:3072 lds
    s_add_u32 s8, s8, 4096
    s_mov_b32 m0, s8
    s_nop 0
    buffer_load_dwordx4 v12, s[16:19], s26 offen lds
    s_add_u32 s26, s26, 81920
    s_waitcnt vmcnt(9)
    s_barrier
    s_add_u32 s8, s30, 36864
    s_mov_b32 m0, s8
    s_nop 0
    buffer_load_dwordx4 v2, s[12:15], s24 offen sc1 lds
    buffer_load_dwordx4 v2, s[12:15], s24 offen offset:1024 sc1 lds
    s_add_u32 s24, s24, 2048
    s_add_u32 s8, s30, 45056
    s_mov_b32 m0, s8
    s_nop 0
    buffer_load_dwordx4 v2, s[12:15], s25 offen sc1 lds
    buffer_load_dwordx4 v2, s[12:15], s25 offen offset:1024 sc1 lds
    s_add_u32 s25, s25, 2048
    s_add_u32 s8, s32, 53248
    s_mov_b32 m0, s8
    s_nop 0
    buffer_load_dwordx4 v8, s[16:19], s26 offen lds
    buffer_load_dwordx4 v9, s[16:19], s26 offen offset:1024 lds
    buffer_load_dwordx4 v10, s[16:19], s26 offen offset:2048 lds
    buffer_load_dwordx4 v11, s[16:19], s26 offen offset:3072 lds
    s_add_u32 s8, s8, 4096
    s_mov_b32 m0, s8
    s_nop 0
    buffer_load_dwordx4 v12, s[16:19], s26 offen lds
    s_add_u32 s26, s26, 81920
    s_add_u32 s52, s52, 2
    s_cmp_eq_u32 s52, 16
    s_cselect_b32 s8, 32768, 0
    s_cselect_b32 s9, 1310720, 0
    s_sub_u32 s24, s24, s8
    s_sub_u32 s25, s25, s8
    s_sub_u32 s26, s26, s9
    s_cmp_lg_u32 s3, 4
    s_cbranch_scc1 L_op_ck5
    s_add_u32 s10, s50, 5
    s_and_b32 s10, s10, 7
    s_lshl_b32 s10, 1, s10
    s_mov_b32 s53, 0
L_op_pl5:
    s_and_b32 s8, s51, s10
    s_cbranch_scc1 L_op_ck5
    buffer_load_dword v22, v21, s[44:47], s34 offen sc1
    s_waitcnt vmcnt(0)
    v_readfirstlane_b32 s51, v22
    s_add_u32 s53, s53, 1
    s_cmp_lt_u32 s53, 2097152
    s_cbranch_scc1 L_op_pl5
L_op_ck5:
    s_waitcnt vmcnt(9)
    s_barrier
    s_add_u32 s8, s30, 73728
    s_mov_b32 m0, s8
    s_nop 0
    buffer_load_dwordx4 v2, s[12:15], s24 offen sc1 lds
    buffer_load_dwordx4 v2, s[12:15], s24 offen offset:1024 sc1 lds
    s_add_u32 s24, s24, 2048
    s_add_u32 s8, s30, 81920
    s_mov_b32 m0, s8
    s_nop 0
    buffer_load_dwordx4 v2, s[12:15], s25 offen sc1 lds
    buffer_load_dwordx4 v2, s[12:15], s25 offen offset:1024 sc1 lds
    s_add_u32 s25, s25, 2048
    s_add_u32 s8, s32, 90112
    s_mov_b32 m0, s8
    s_nop 0
    buffer_load_dwordx4 v8, s[16:19], s26 offen lds
    buffer_load_dwordx4 v9, s[16:19], s26 offen offset:1024 lds
    buffer_load_dwordx4 v10, s[16:19], s26 offen offset:2048 lds
    buffer_load_dwordx4 v11, s[16:19], s26 offen offset:3072 lds
    s_add_u32 s8, s8, 4096
    s_mov_b32 m0, s8
    s_nop 0
    buffer_load_dwordx4 v12, s[16:19], s26 offen lds
    s_add_u32 s26, s26, 81920
    s_waitcnt vmcnt(9)
    s_barrier
    s_add_u32 s8, s30, 110592
    s_mov_b32 m0, s8
    s_nop 0
    buffer_load_dwordx4 v2, s[12:15], s24 offen sc1 lds
    buffer_load_dwordx4 v2, s[12:15], s24 offen offset:1024 sc1 lds
    s_add_u32 s24, s24, 2048
    s_add_u32 s8, s30, 118784
    s_mov_b32 m0, s8
    s_nop 0
    buffer_load_dwordx4 v2, s[12:15], s25 offen sc1 lds
    buffer_load_dwordx4 v2, s[12:15], s25 offen offset:1024 sc1 lds
    s_add_u32 s25, s25, 2048
    s_add_u32 s8, s32, 126976
    s_mov_b32 m0, s8
    s_nop 0
    buffer_load_dwordx4 v8, s[16:19], s26 offen lds
    buffer_load_dwordx4 v9, s[16:19], s26 offen offset:1024 lds
    buffer_load_dwordx4 v10, s[16:19], s26 offen offset:2048 lds
    buffer_load_dwordx4 v11, s[16:19], s26 offen offset:3072 lds
    s_add_u32 s8, s8, 4096
    s_mov_b32 m0, s8
    s_nop 0
    buffer_load_dwordx4 v12, s[16:19], s26 offen lds
    s_add_u32 s26, s26, 81920
    s_add_u32 s52, s52, 2
    s_cmp_eq_u32 s52, 16
    s_cselect_b32 s8, 32768, 0
    s_cselect_b32 s9, 1310720, 0
    s_sub_u32 s24, s24, s8
    s_sub_u32 s25, s25, s8
    s_sub_u32 s26, s26, s9
    s_cmp_lg_u32 s3, 4
    s_cbranch_scc1 L_op_ck6
    s_add_u32 s10, s50, 6
    s_and_b32 s10, s10, 7
    s_lshl_b32 s10, 1, s10
    s_mov_b32 s53, 0
L_op_pl6:
    s_and_b32 s8, s51, s10
    s_cbranch_scc1 L_op_ck6
    buffer_load_dword v22, v21, s[44:47], s34 offen sc1
    s_waitcnt vmcnt(0)
    v_readfirstlane_b32 s51, v22
    s_add_u32 s53, s53, 1
    s_cmp_lt_u32 s53, 2097152
    s_cbranch_scc1 L_op_pl6
L_op_ck6:
    s_waitcnt vmcnt(9)
    s_barrier
    s_add_u32 s8, s30, 0
    s_mov_b32 m0, s8
    s_nop 0
    buffer_load_dwordx4 v2, s[12:15], s24 offen sc1 lds
    buffer_load_dwordx4 v2, s[12:15], s24 offen offset:1024 sc1 lds
    s_add_u32 s24, s24, 2048
    s_add_u32 s8, s30, 8192
    s_mov_b32 m0, s8
    s_nop 0
    buffer_load_dwordx4 v2, s[12:15], s25 offen sc1 lds
    buffer_load_dwordx4 v2, s[12:15], s25 offen offset:1024 sc1 lds
    s_add_u32 s25, s25, 2048
    s_add_u32 s8, s32, 16384
    s_mov_b32 m0, s8
    s_nop 0
    buffer_load_dwordx4 v8, s[16:19], s26 offen lds
    buffer_load_dwordx4 v9, s[16:19], s26 offen offset:1024 lds
    buffer_load_dwordx4 v10, s[16:19], s26 offen offset:2048 lds
    buffer_load_dwordx4 v11, s[16:19], s26 offen offset:3072 lds
    s_add_u32 s8, s8, 4096
    s_mov_b32 m0, s8
    s_nop 0
    buffer_load_dwordx4 v12, s[16:19], s26 offen lds
    s_add_u32 s26, s26, 81920
    s_waitcnt vmcnt(9)
    s_barrier
    s_add_u32 s8, s30, 36864
    s_mov_b32 m0, s8
    s_nop 0
    buffer_load_dwordx4 v2, s[12:15], s24 offen sc1 lds
    buffer_load_dwordx4 v2, s[12:15], s24 offen offset:1024 sc1 lds
    s_add_u32 s24, s24, 2048
    s_add_u32 s8, s30, 45056
    s_mov_b32 m0, s8
    s_nop 0
    buffer_load_dwordx4 v2, s[12:15], s25 offen sc1 lds
    buffer_load_dwordx4 v2, s[12:15], s25 offen offset:1024 sc1 lds
    s_add_u32 s25, s25, 2048
    s_add_u32 s8, s32, 53248
    s_mov_b32 m0, s8
    s_nop 0
    buffer_load_dwordx4 v8, s[16:19], s26 offen lds
    buffer_load_dwordx4 v9, s[16:19], s26 offen offset:1024 lds
    buffer_load_dwordx4 v10, s[16:19], s26 offen offset:2048 lds
    buffer_load_dwordx4 v11, s[16:19], s26 offen offset:3072 lds
    s_add_u32 s8, s8, 4096
    s_mov_b32 m0, s8
    s_nop 0
    buffer_load_dwordx4 v12, s[16:19], s26 offen lds
    s_add_u32 s26, s26, 81920
    s_add_u32 s52, s52, 2
    s_cmp_eq_u32 s52, 16
    s_cselect_b32 s8, 32768, 0
    s_cselect_b32 s9, 1310720, 0
    s_sub_u32 s24, s24, s8
    s_sub_u32 s25, s25, s8
    s_sub_u32 s26, s26, s9
    s_cmp_lg_u32 s3, 4
    s_cbranch_scc1 L_op_ck7
    s_add_u32 s10, s50, 7
    s_and_b32 s10, s10, 7
    s_lshl_b32 s10, 1, s10
    s_mov_b32 s53, 0
L_op_pl7:
    s_and_b32 s8, s51, s10
    s_cbranch_scc1 L_op_ck7
    buffer_load_dword v22, v21, s[44:47], s34 offen sc1
    s_waitcnt vmcnt(0)
    v_readfirstlane_b32 s51, v22
    s_add_u32 s53, s53, 1
    s_cmp_lt_u32 s53, 2097152
    s_cbranch_scc1 L_op_pl7
L_op_ck7:
    s_waitcnt vmcnt(9)
    s_barrier
    s_add_u32 s8, s30, 73728
    s_mov_b32 m0, s8
    s_nop 0
    buffer_load_dwordx4 v2, s[12:15], s24 offen sc1 lds
    buffer_load_dwordx4 v2, s[12:15], s24 offen offset:1024 sc1 lds
    s_add_u32 s24, s24, 2048
    s_add_u32 s8, s30, 81920
    s_mov_b32 m0, s8
    s_nop 0
    buffer_load_dwordx4 v2, s[12:15], s25 offen sc1 lds
    buffer_load_dwordx4 v2, s[12:15], s25 offen offset:1024 sc1 lds
    s_add_u32 s25, s25, 2048
    s_add_u32 s8, s32, 90112
    s_mov_b32 m0, s8
    s_nop 0
    buffer_load_dwordx4 v8, s[16:19], s26 offen lds
    buffer_load_dwordx4 v9, s[16:19], s26 offen offset:1024 lds
    buffer_load_dwordx4 v10, s[16:19], s26 offen offset:2048 lds
    buffer_load_dwordx4 v11, s[16:19], s26 offen offset:3072 lds
    s_add_u32 s8, s8, 4096
    s_mov_b32 m0, s8
    s_nop 0
    buffer_load_dwordx4 v12, s[16:19], s26 offen lds
    s_add_u32 s26, s26, 81920
    s_waitcnt vmcnt(9)
    s_barrier
    s_add_u32 s8, s30, 110592
    s_mov_b32 m0, s8
    s_nop 0
    buffer_load_dwordx4 v2, s[12:15], s24 offen sc1 lds
    buffer_load_dwordx4 v2, s[12:15], s24 offen offset:1024 sc1 lds
    s_add_u32 s24, s24, 2048
    s_add_u32 s8, s30, 118784
    s_mov_b32 m0, s8
    s_nop 0
    buffer_load_dwordx4 v2, s[12:15], s25 offen sc1 lds
    buffer_load_dwordx4 v2, s[12:15], s25 offen offset:1024 sc1 lds
    s_add_u32 s25, s25, 2048
    s_add_u32 s8, s32, 126976
    s_mov_b32 m0, s8
    s_nop 0
    buffer_load_dwordx4 v8, s[16:19], s26 offen lds
    buffer_load_dwordx4 v9, s[16:19], s26 offen offset:1024 lds
    buffer_load_dwordx4 v10, s[16:19], s26 offen offset:2048 lds
    buffer_load_dwordx4 v11, s[16:19], s26 offen offset:3072 lds
    s_add_u32 s8, s8, 4096
    s_mov_b32 m0, s8
    s_nop 0
    buffer_load_dwordx4 v12, s[16:19], s26 offen lds
    s_add_u32 s26, s26, 81920
    s_add_u32 s52, s52, 2
    s_cmp_eq_u32 s52, 16
    s_cselect_b32 s8, 32768, 0
    s_cselect_b32 s9, 1310720, 0
    s_sub_u32 s24, s24, s8
    s_sub_u32 s25, s25, s8
    s_sub_u32 s26, s26, s9
    s_waitcnt vmcnt(9)
    s_barrier
    s_waitcnt vmcnt(0)
    s_barrier
    s_barrier
    s_branch L_op_done
L_op_compute:
    s_and_b32 s31, s3, 1
    s_lshr_b32 s32, s3, 1
    s_lshl_b32 s33, s4, 3
    s_add_u32 s33, s33, s6
    s_lshl_b32 s33, s33, 2
    s_add_u32 s33, s33, s7
    s_lshl_b32 s8, s31, 13
    v_add_u32 v4, s8, v2
    v_lshrrev_b32 v16, 4, v1
    v_bfe_u32 v17, v1, 2, 2
    v_lshl_add_u32 v17, v16, 3, v17
    v_mul_u32_u24 v17, 320, v17
    v_bfe_u32 v18, v1, 1, 1
    v_and_b32 v19, 1, v16
    v_lshl_add_u32 v18, v19, 1, v18
    v_lshl_add_u32 v17, v18, 4, v17
    v_and_b32 v18, 1, v1
    v_lshl_add_u32 v17, v18, 3, v17
    s_mul_i32 s9, s32, 160
    s_add_u32 s9, s9, 16384
    v_add_u32 v5, s9, v17
    s_mul_i32 s9, s32, 320
    v_mul_lo_u32 v19, v19, s9
    v_sub_u32 v6, v5, v19
    v_add_u32 v7, 36864, v4
    v_add_u32 v8, 36864, v5
    v_add_u32 v9, 36864, v6
    v_add_u32 v10, 73728, v4
    v_add_u32 v11, 73728, v5
    v_add_u32 v12, 73728, v6
    v_add_u32 v13, 110592, v4
    v_add_u32 v14, 110592, v5
    v_add_u32 v15, 110592, v6
    s_barrier
    ds_read_b128 v[120:123], v4
    ds_read_b128 v[124:127], v4 offset:2048
    ds_read_b128 v[128:131], v4 offset:4096
    ds_read_b128 v[132:135], v4 offset:6144
    ds_read_b64_tr_b16 v[100:101], v5
    ds_read_b64_tr_b16 v[102:103], v5 offset:1280
    ds_read_b64_tr_b16 v[104:105], v5 offset:32
    ds_read_b64_tr_b16 v[106:107], v5 offset:1312
    ds_read_b64_tr_b16 v[108:109], v5 offset:64
    ds_read_b64_tr_b16 v[110:111], v5 offset:1344
    ds_read_b64_tr_b16 v[112:113], v5 offset:96
    ds_read_b64_tr_b16 v[114:115], v5 offset:1376
    ds_read_b64_tr_b16 v[116:117], v6 offset:128
    ds_read_b64_tr_b16 v[118:119], v6 offset:1408
    s_waitcnt lgkmcnt(0)
    v_mfma_f32_16x16x32_bf16 v[20:23], v[100:103], v[120:123], 0
    ds_read_b128 v[156:159], v4 offset:1024
    v_mfma_f32_16x16x32_bf16 v[24:27], v[100:103], v[124:127], 0
    ds_read_b128 v[160:163], v4 offset:3072
    v_mfma_f32_16x16x32_bf16 v[28:31], v[100:103], v[128:131], 0
    ds_read_b128 v[164:167], v4 offset:5120
    v_mfma_f32_16x16x32_bf16 v[32:35], v[100:103], v[132:135], 0
    ds_read_b128 v[168:171], v4 offset:7168
    v_mfma_f32_16x16x32_bf16 v[36:39], v[104:107], v[120:123], 0
    ds_read_b64_tr_b16 v[136:137], v5 offset:10240
    v_mfma_f32_16x16x32_bf16 v[40:43], v[104:107], v[124:127], 0
    ds_read_b64_tr_b16 v[138:139], v5 offset:11520
    v_mfma_f32_16x16x32_bf16 v[44:47], v[104:107], v[128:131], 0
    ds_read_b64_tr_b16 v[140:141], v5 offset:10272
    v_mfma_f32_16x16x32_bf16 v[48:51], v[104:107], v[132:135], 0
    ds_read_b64_tr_b16 v[142:143], v5 offset:11552
    v_mfma_f32_16x16x32_bf16 v[52:55], v[108:111], v[120:123], 0
    ds_read_b64_tr_b16 v[144:145], v5 offset:10304
    v_mfma_f32_16x16x32_bf16 v[56:59], v[108:111], v[124:127], 0
    ds_read_b64_tr_b16 v[146:147], v5 offset:11584
    v_mfma_f32_16x16x32_bf16 v[60:63], v[108:111], v[128:131], 0
    ds_read_b64_tr_b16 v[148:149], v5 offset:10336
    v_mfma_f32_16x16x32_bf16 v[64:67], v[108:111], v[132:135], 0
    ds_read_b64_tr_b16 v[150:151], v5 offset:11616
    v_mfma_f32_16x16x32_bf16 v[68:71], v[112:115], v[120:123], 0
    ds_read_b64_tr_b16 v[152:153], v6 offset:10368
    v_mfma_f32_16x16x32_bf16 v[72:75], v[112:115], v[124:127], 0
    ds_read_b64_tr_b16 v[154:155], v6 offset:11648
    v_mfma_f32_16x16x32_bf16 v[76:79], v[112:115], v[128:131], 0
    v_mfma_f32_16x16x32_bf16 v[80:83], v[112:115], v[132:135], 0
    v_mfma_f32_16x16x32_bf16 v[84:87], v[116:119], v[120:123], 0
    v_mfma_f32_16x16x32_bf16 v[88:91], v[116:119], v[124:127], 0
    v_mfma_f32_16x16x32_bf16 v[92:95], v[116:119], v[128:131], 0
    v_mfma_f32_16x16x32_bf16 v[96:99], v[116:119], v[132:135], 0
    s_waitcnt lgkmcnt(0)
    v_mfma_f32_16x16x32_bf16 v[20:23], v[136:139], v[156:159], v[20:23]
    ds_read_b128 v[120:123], v7
    v_mfma_f32_16x16x32_bf16 v[24:27], v[136:139], v[160:163], v[24:27]
    ds_read_b128 v[124:127], v7 offset:2048
    v_mfma_f32_16x16x32_bf16 v[28:31], v[136:139], v[164:167], v[28:31]
    ds_read_b128 v[128:131], v7 offset:4096
    v_mfma_f32_16x16x32_bf16 v[32:35], v[136:139], v[168:171], v[32:35]
    ds_read_b128 v[132:135], v7 offset:6144
    v_mfma_f32_16x16x32_bf16 v[36:39], v[140:143], v[156:159], v[36:39]
    ds_read_b64_tr_b16 v[100:101], v8
    v_mfma_f32_16x16x32_bf16 v[40:43], v[140:143], v[160:163], v[40:43]
    ds_read_b64_tr_b16 v[102:103], v8 offset:1280
    v_mfma_f32_16x16x32_bf16 v[44:47], v[140:143], v[164:167], v[44:47]
    ds_read_b64_tr_b16 v[104:105], v8 offset:32
    v_mfma_f32_16x16x32_bf16 v[48:51], v[140:143], v[168:171], v[48:51]
    ds_read_b64_tr_b16 v[106:107], v8 offset:1312
    v_mfma_f32_16x16x32_bf16 v[52:55], v[144:147], v[156:159], v[52:55]
    ds_read_b64_tr_b16 v[108:109], v8 offset:64
    v_mfma_f32_16x16x32_bf16 v[56:59], v[144:147], v[160:163], v[56:59]
    ds_read_b64_tr_b16 v[110:111], v8 offset:1344
    v_mfma_f32_16x16x32_bf16 v[60:63], v[144:147], v[164:167], v[60:63]
    ds_read_b64_tr_b16 v[112:113], v8 offset:96
    v_mfma_f32_16x16x32_bf16 v[64:67], v[144:147], v[168:171], v[64:67]
    ds_read_b64_tr_b16 v[114:115], v8 offset:1376
    v_mfma_f32_16x16x32_bf16 v[68:71], v[148:151], v[156:159], v[68:71]
    ds_read_b64_tr_b16 v[116:117], v9 offset:128
    v_mfma_f32_16x16x32_bf16 v[72:75], v[148:151], v[160:163], v[72:75]
    ds_read_b64_tr_b16 v[118:119], v9 offset:1408
    v_mfma_f32_16x16x32_bf16 v[76:79], v[148:151], v[164:167], v[76:79]
    v_mfma_f32_16x16x32_bf16 v[80:83], v[148:151], v[168:171], v[80:83]
    v_mfma_f32_16x16x32_bf16 v[84:87], v[152:155], v[156:159], v[84:87]
    v_mfma_f32_16x16x32_bf16 v[88:91], v[152:155], v[160:163], v[88:91]
    v_mfma_f32_16x16x32_bf16 v[92:95], v[152:155], v[164:167], v[92:95]
    v_mfma_f32_16x16x32_bf16 v[96:99], v[152:155], v[168:171], v[96:99]
    s_barrier
    s_waitcnt lgkmcnt(0)
    v_mfma_f32_16x16x32_bf16 v[20:23], v[100:103], v[120:123], v[20:23]
    ds_read_b128 v[156:159], v7 offset:1024
    v_mfma_f32_16x16x32_bf16 v[24:27], v[100:103], v[124:127], v[24:27]
    ds_read_b128 v[160:163], v7 offset:3072
    v_mfma_f32_16x16x32_bf16 v[28:31], v[100:103], v[128:131], v[28:31]
    ds_read_b128 v[164:167], v7 offset:5120
    v_mfma_f32_16x16x32_bf16 v[32:35], v[100:103], v[132:135], v[32:35]
    ds_read_b128 v[168:171], v7 offset:7168
    v_mfma_f32_16x16x32_bf16 v[36:39], v[104:107], v[120:123], v[36:39]
    ds_read_b64_tr_b16 v[136:137], v8 offset:10240
    v_mfma_f32_16x16x32_bf16 v[40:43], v[104:107], v[124:127], v[40:43]
    ds_read_b64_tr_b16 v[138:139], v8 offset:11520
    v_mfma_f32_16x16x32_bf16 v[44:47], v[104:107], v[128:131], v[44:47]
    ds_read_b64_tr_b16 v[140:141], v8 offset:10272
    v_mfma_f32_16x16x32_bf16 v[48:51], v[104:107], v[132:135], v[48:51]
    ds_read_b64_tr_b16 v[142:143], v8 offset:11552
    v_mfma_f32_16x16x32_bf16 v[52:55], v[108:111], v[120:123], v[52:55]
    ds_read_b64_tr_b16 v[144:145], v8 offset:10304
    v_mfma_f32_16x16x32_bf16 v[56:59], v[108:111], v[124:127], v[56:59]
    ds_read_b64_tr_b16 v[146:147], v8 offset:11584
    v_mfma_f32_16x16x32_bf16 v[60:63], v[108:111], v[128:131], v[60:63]
    ds_read_b64_tr_b16 v[148:149], v8 offset:10336
    v_mfma_f32_16x16x32_bf16 v[64:67], v[108:111], v[132:135], v[64:67]
    ds_read_b64_tr_b16 v[150:151], v8 offset:11616
    v_mfma_f32_16x16x32_bf16 v[68:71], v[112:115], v[120:123], v[68:71]
    ds_read_b64_tr_b16 v[152:153], v9 offset:10368
    v_mfma_f32_16x16x32_bf16 v[72:75], v[112:115], v[124:127], v[72:75]
    ds_read_b64_tr_b16 v[154:155], v9 offset:11648
    v_mfma_f32_16x16x32_bf16 v[76:79], v[112:115], v[128:131], v[76:79]
    v_mfma_f32_16x16x32_bf16 v[80:83], v[112:115], v[132:135], v[80:83]
    v_mfma_f32_16x16x32_bf16 v[84:87], v[116:119], v[120:123], v[84:87]
    v_mfma_f32_16x16x32_bf16 v[88:91], v[116:119], v[124:127], v[88:91]
    v_mfma_f32_16x16x32_bf16 v[92:95], v[116:119], v[128:131], v[92:95]
    v_mfma_f32_16x16x32_bf16 v[96:99], v[116:119], v[132:135], v[96:99]
    s_waitcnt lgkmcnt(0)
    v_mfma_f32_16x16x32_bf16 v[20:23], v[136:139], v[156:159], v[20:23]
    ds_read_b128 v[120:123], v10
    v_mfma_f32_16x16x32_bf16 v[24:27], v[136:139], v[160:163], v[24:27]
    ds_read_b128 v[124:127], v10 offset:2048
    v_mfma_f32_16x16x32_bf16 v[28:31], v[136:139], v[164:167], v[28:31]
    ds_read_b128 v[128:131], v10 offset:4096
    v_mfma_f32_16x16x32_bf16 v[32:35], v[136:139], v[168:171], v[32:35]
    ds_read_b128 v[132:135], v10 offset:6144
    v_mfma_f32_16x16x32_bf16 v[36:39], v[140:143], v[156:159], v[36:39]
    ds_read_b64_tr_b16 v[100:101], v11
    v_mfma_f32_16x16x32_bf16 v[40:43], v[140:143], v[160:163], v[40:43]
    ds_read_b64_tr_b16 v[102:103], v11 offset:1280
    v_mfma_f32_16x16x32_bf16 v[44:47], v[140:143], v[164:167], v[44:47]
    ds_read_b64_tr_b16 v[104:105], v11 offset:32
    v_mfma_f32_16x16x32_bf16 v[48:51], v[140:143], v[168:171], v[48:51]
    ds_read_b64_tr_b16 v[106:107], v11 offset:1312
    v_mfma_f32_16x16x32_bf16 v[52:55], v[144:147], v[156:159], v[52:55]
    ds_read_b64_tr_b16 v[108:109], v11 offset:64
    v_mfma_f32_16x16x32_bf16 v[56:59], v[144:147], v[160:163], v[56:59]
    ds_read_b64_tr_b16 v[110:111], v11 offset:1344
    v_mfma_f32_16x16x32_bf16 v[60:63], v[144:147], v[164:167], v[60:63]
    ds_read_b64_tr_b16 v[112:113], v11 offset:96
    v_mfma_f32_16x16x32_bf16 v[64:67], v[144:147], v[168:171], v[64:67]
    ds_read_b64_tr_b16 v[114:115], v11 offset:1376
    v_mfma_f32_16x16x32_bf16 v[68:71], v[148:151], v[156:159], v[68:71]
    ds_read_b64_tr_b16 v[116:117], v12 offset:128
    v_mfma_f32_16x16x32_bf16 v[72:75], v[148:151], v[160:163], v[72:75]
    ds_read_b64_tr_b16 v[118:119], v12 offset:1408
    v_mfma_f32_16x16x32_bf16 v[76:79], v[148:151], v[164:167], v[76:79]
    v_mfma_f32_16x16x32_bf16 v[80:83], v[148:151], v[168:171], v[80:83]
    v_mfma_f32_16x16x32_bf16 v[84:87], v[152:155], v[156:159], v[84:87]
    v_mfma_f32_16x16x32_bf16 v[88:91], v[152:155], v[160:163], v[88:91]
    v_mfma_f32_16x16x32_bf16 v[92:95], v[152:155], v[164:167], v[92:95]
    v_mfma_f32_16x16x32_bf16 v[96:99], v[152:155], v[168:171], v[96:99]
    s_barrier
    s_waitcnt lgkmcnt(0)
    v_mfma_f32_16x16x32_bf16 v[20:23], v[100:103], v[120:123], v[20:23]
    ds_read_b128 v[156:159], v10 offset:1024
    v_mfma_f32_16x16x32_bf16 v[24:27], v[100:103], v[124:127], v[24:27]
    ds_read_b128 v[160:163], v10 offset:3072
    v_mfma_f32_16x16x32_bf16 v[28:31], v[100:103], v[128:131], v[28:31]
    ds_read_b128 v[164:167], v10 offset:5120
    v_mfma_f32_16x16x32_bf16 v[32:35], v[100:103], v[132:135], v[32:35]
    ds_read_b128 v[168:171], v10 offset:7168
    v_mfma_f32_16x16x32_bf16 v[36:39], v[104:107], v[120:123], v[36:39]
    ds_read_b64_tr_b16 v[136:137], v11 offset:10240
    v_mfma_f32_16x16x32_bf16 v[40:43], v[104:107], v[124:127], v[40:43]
    ds_read_b64_tr_b16 v[138:139], v11 offset:11520
    v_mfma_f32_16x16x32_bf16 v[44:47], v[104:107], v[128:131], v[44:47]
    ds_read_b64_tr_b16 v[140:141], v11 offset:10272
    v_mfma_f32_16x16x32_bf16 v[48:51], v[104:107], v[132:135], v[48:51]
    ds_read_b64_tr_b16 v[142:143], v11 offset:11552
    v_mfma_f32_16x16x32_bf16 v[52:55], v[108:111], v[120:123], v[52:55]
    ds_read_b64_tr_b16 v[144:145], v11 offset:10304
    v_mfma_f32_16x16x32_bf16 v[56:59], v[108:111], v[124:127], v[56:59]
    ds_read_b64_tr_b16 v[146:147], v11 offset:11584
    v_mfma_f32_16x16x32_bf16 v[60:63], v[108:111], v[128:131], v[60:63]
    ds_read_b64_tr_b16 v[148:149], v11 offset:10336
    v_mfma_f32_16x16x32_bf16 v[64:67], v[108:111], v[132:135], v[64:67]
    ds_read_b64_tr_b16 v[150:151], v11 offset:11616
    v_mfma_f32_16x16x32_bf16 v[68:71], v[112:115], v[120:123], v[68:71]
    ds_read_b64_tr_b16 v[152:153], v12 offset:10368
    v_mfma_f32_16x16x32_bf16 v[72:75], v[112:115], v[124:127], v[72:75]
    ds_read_b64_tr_b16 v[154:155], v12 offset:11648
    v_mfma_f32_16x16x32_bf16 v[76:79], v[112:115], v[128:131], v[76:79]
    v_mfma_f32_16x16x32_bf16 v[80:83], v[112:115], v[132:135], v[80:83]
    v_mfma_f32_16x16x32_bf16 v[84:87], v[116:119], v[120:123], v[84:87]
    v_mfma_f32_16x16x32_bf16 v[88:91], v[116:119], v[124:127], v[88:91]
    v_mfma_f32_16x16x32_bf16 v[92:95], v[116:119], v[128:131], v[92:95]
    v_mfma_f32_16x16x32_bf16 v[96:99], v[116:119], v[132:135], v[96:99]
    s_waitcnt lgkmcnt(0)
    v_mfma_f32_16x16x32_bf16 v[20:23], v[136:139], v[156:159], v[20:23]
    ds_read_b128 v[120:123], v13
    v_mfma_f32_16x16x32_bf16 v[24:27], v[136:139], v[160:163], v[24:27]
    ds_read_b128 v[124:127], v13 offset:2048
    v_mfma_f32_16x16x32_bf16 v[28:31], v[136:139], v[164:167], v[28:31]
    ds_read_b128 v[128:131], v13 offset:4096
    v_mfma_f32_16x16x32_bf16 v[32:35], v[136:139], v[168:171], v[32:35]
    ds_read_b128 v[132:135], v13 offset:6144
    v_mfma_f32_16x16x32_bf16 v[36:39], v[140:143], v[156:159], v[36:39]
    ds_read_b64_tr_b16 v[100:101], v14
    v_mfma_f32_16x16x32_bf16 v[40:43], v[140:143], v[160:163], v[40:43]
    ds_read_b64_tr_b16 v[102:103], v14 offset:1280
    v_mfma_f32_16x16x32_bf16 v[44:47], v[140:143], v[164:167], v[44:47]
    ds_read_b64_tr_b16 v[104:105], v14 offset:32
    v_mfma_f32_16x16x32_bf16 v[48:51], v[140:143], v[168:171], v[48:51]
    ds_read_b64_tr_b16 v[106:107], v14 offset:1312
    v_mfma_f32_16x16x32_bf16 v[52:55], v[144:147], v[156:159], v[52:55]
    ds_read_b64_tr_b16 v[108:109], v14 offset:64
    v_mfma_f32_16x16x32_bf16 v[56:59], v[144:147], v[160:163], v[56:59]
    ds_read_b64_tr_b16 v[110:111], v14 offset:1344
    v_mfma_f32_16x16x32_bf16 v[60:63], v[144:147], v[164:167], v[60:63]
    ds_read_b64_tr_b16 v[112:113], v14 offset:96
    v_mfma_f32_16x16x32_bf16 v[64:67], v[144:147], v[168:171], v[64:67]
    ds_read_b64_tr_b16 v[114:115], v14 offset:1376
    v_mfma_f32_16x16x32_bf16 v[68:71], v[148:151], v[156:159], v[68:71]
    ds_read_b64_tr_b16 v[116:117], v15 offset:128
    v_mfma_f32_16x16x32_bf16 v[72:75], v[148:151], v[160:163], v[72:75]
    ds_read_b64_tr_b16 v[118:119], v15 offset:1408
    v_mfma_f32_16x16x32_bf16 v[76:79], v[148:151], v[164:167], v[76:79]
    v_mfma_f32_16x16x32_bf16 v[80:83], v[148:151], v[168:171], v[80:83]
    v_mfma_f32_16x16x32_bf16 v[84:87], v[152:155], v[156:159], v[84:87]
    v_mfma_f32_16x16x32_bf16 v[88:91], v[152:155], v[160:163], v[88:91]
    v_mfma_f32_16x16x32_bf16 v[92:95], v[152:155], v[164:167], v[92:95]
    v_mfma_f32_16x16x32_bf16 v[96:99], v[152:155], v[168:171], v[96:99]
    s_barrier
    s_waitcnt lgkmcnt(0)
    v_mfma_f32_16x16x32_bf16 v[20:23], v[100:103], v[120:123], v[20:23]
    ds_read_b128 v[156:159], v13 offset:1024
    v_mfma_f32_16x16x32_bf16 v[24:27], v[100:103], v[124:127], v[24:27]
    ds_read_b128 v[160:163], v13 offset:3072
    v_mfma_f32_16x16x32_bf16 v[28:31], v[100:103], v[128:131], v[28:31]
    ds_read_b128 v[164:167], v13 offset:5120
    v_mfma_f32_16x16x32_bf16 v[32:35], v[100:103], v[132:135], v[32:35]
    ds_read_b128 v[168:171], v13 offset:7168
    v_mfma_f32_16x16x32_bf16 v[36:39], v[104:107], v[120:123], v[36:39]
    ds_read_b64_tr_b16 v[136:137], v14 offset:10240
    v_mfma_f32_16x16x32_bf16 v[40:43], v[104:107], v[124:127], v[40:43]
    ds_read_b64_tr_b16 v[138:139], v14 offset:11520
    v_mfma_f32_16x16x32_bf16 v[44:47], v[104:107], v[128:131], v[44:47]
    ds_read_b64_tr_b16 v[140:141], v14 offset:10272
    v_mfma_f32_16x16x32_bf16 v[48:51], v[104:107], v[132:135], v[48:51]
    ds_read_b64_tr_b16 v[142:143], v14 offset:11552
    v_mfma_f32_16x16x32_bf16 v[52:55], v[108:111], v[120:123], v[52:55]
    ds_read_b64_tr_b16 v[144:145], v14 offset:10304
    v_mfma_f32_16x16x32_bf16 v[56:59], v[108:111], v[124:127], v[56:59]
    ds_read_b64_tr_b16 v[146:147], v14 offset:11584
    v_mfma_f32_16x16x32_bf16 v[60:63], v[108:111], v[128:131], v[60:63]
    ds_read_b64_tr_b16 v[148:149], v14 offset:10336
    v_mfma_f32_16x16x32_bf16 v[64:67], v[108:111], v[132:135], v[64:67]
    ds_read_b64_tr_b16 v[150:151], v14 offset:11616
    v_mfma_f32_16x16x32_bf16 v[68:71], v[112:115], v[120:123], v[68:71]
    ds_read_b64_tr_b16 v[152:153], v15 offset:10368
    v_mfma_f32_16x16x32_bf16 v[72:75], v[112:115], v[124:127], v[72:75]
    ds_read_b64_tr_b16 v[154:155], v15 offset:11648
    v_mfma_f32_16x16x32_bf16 v[76:79], v[112:115], v[128:131], v[76:79]
    v_mfma_f32_16x16x32_bf16 v[80:83], v[112:115], v[132:135], v[80:83]
    v_mfma_f32_16x16x32_bf16 v[84:87], v[116:119], v[120:123], v[84:87]
    v_mfma_f32_16x16x32_bf16 v[88:91], v[116:119], v[124:127], v[88:91]
    v_mfma_f32_16x16x32_bf16 v[92:95], v[116:119], v[128:131], v[92:95]
    v_mfma_f32_16x16x32_bf16 v[96:99], v[116:119], v[132:135], v[96:99]
    s_waitcnt lgkmcnt(0)
    v_mfma_f32_16x16x32_bf16 v[20:23], v[136:139], v[156:159], v[20:23]
    ds_read_b128 v[120:123], v4
    v_mfma_f32_16x16x32_bf16 v[24:27], v[136:139], v[160:163], v[24:27]
    ds_read_b128 v[124:127], v4 offset:2048
    v_mfma_f32_16x16x32_bf16 v[28:31], v[136:139], v[164:167], v[28:31]
    ds_read_b128 v[128:131], v4 offset:4096
    v_mfma_f32_16x16x32_bf16 v[32:35], v[136:139], v[168:171], v[32:35]
    ds_read_b128 v[132:135], v4 offset:6144
    v_mfma_f32_16x16x32_bf16 v[36:39], v[140:143], v[156:159], v[36:39]
    ds_read_b64_tr_b16 v[100:101], v5
    v_mfma_f32_16x16x32_bf16 v[40:43], v[140:143], v[160:163], v[40:43]
    ds_read_b64_tr_b16 v[102:103], v5 offset:1280
    v_mfma_f32_16x16x32_bf16 v[44:47], v[140:143], v[164:167], v[44:47]
    ds_read_b64_tr_b16 v[104:105], v5 offset:32
    v_mfma_f32_16x16x32_bf16 v[48:51], v[140:143], v[168:171], v[48:51]
    ds_read_b64_tr_b16 v[106:107], v5 offset:1312
    v_mfma_f32_16x16x32_bf16 v[52:55], v[144:147], v[156:159], v[52:55]
    ds_read_b64_tr_b16 v[108:109], v5 offset:64
    v_mfma_f32_16x16x32_bf16 v[56:59], v[144:147], v[160:163], v[56:59]
    ds_read_b64_tr_b16 v[110:111], v5 offset:1344
    v_mfma_f32_16x16x32_bf16 v[60:63], v[144:147], v[164:167], v[60:63]
    ds_read_b64_tr_b16 v[112:113], v5 offset:96
    v_mfma_f32_16x16x32_bf16 v[64:67], v[144:147], v[168:171], v[64:67]
    ds_read_b64_tr_b16 v[114:115], v5 offset:1376
    v_mfma_f32_16x16x32_bf16 v[68:71], v[148:151], v[156:159], v[68:71]
    ds_read_b64_tr_b16 v[116:117], v6 offset:128
    v_mfma_f32_16x16x32_bf16 v[72:75], v[148:151], v[160:163], v[72:75]
    ds_read_b64_tr_b16 v[118:119], v6 offset:1408
    v_mfma_f32_16x16x32_bf16 v[76:79], v[148:151], v[164:167], v[76:79]
    v_mfma_f32_16x16x32_bf16 v[80:83], v[148:151], v[168:171], v[80:83]
    v_mfma_f32_16x16x32_bf16 v[84:87], v[152:155], v[156:159], v[84:87]
    v_mfma_f32_16x16x32_bf16 v[88:91], v[152:155], v[160:163], v[88:91]
    v_mfma_f32_16x16x32_bf16 v[92:95], v[152:155], v[164:167], v[92:95]
    v_mfma_f32_16x16x32_bf16 v[96:99], v[152:155], v[168:171], v[96:99]
    s_barrier
    s_waitcnt lgkmcnt(0)
    v_mfma_f32_16x16x32_bf16 v[20:23], v[100:103], v[120:123], v[20:23]
    ds_read_b128 v[156:159], v4 offset:1024
    v_mfma_f32_16x16x32_bf16 v[24:27], v[100:103], v[124:127], v[24:27]
    ds_read_b128 v[160:163], v4 offset:3072
    v_mfma_f32_16x16x32_bf16 v[28:31], v[100:103], v[128:131], v[28:31]
    ds_read_b128 v[164:167], v4 offset:5120
    v_mfma_f32_16x16x32_bf16 v[32:35], v[100:103], v[132:135], v[32:35]
    ds_read_b128 v[168:171], v4 offset:7168
    v_mfma_f32_16x16x32_bf16 v[36:39], v[104:107], v[120:123], v[36:39]
    ds_read_b64_tr_b16 v[136:137], v5 offset:10240
    v_mfma_f32_16x16x32_bf16 v[40:43], v[104:107], v[124:127], v[40:43]
    ds_read_b64_tr_b16 v[138:139], v5 offset:11520
    v_mfma_f32_16x16x32_bf16 v[44:47], v[104:107], v[128:131], v[44:47]
    ds_read_b64_tr_b16 v[140:141], v5 offset:10272
    v_mfma_f32_16x16x32_bf16 v[48:51], v[104:107], v[132:135], v[48:51]
    ds_read_b64_tr_b16 v[142:143], v5 offset:11552
    v_mfma_f32_16x16x32_bf16 v[52:55], v[108:111], v[120:123], v[52:55]
    ds_read_b64_tr_b16 v[144:145], v5 offset:10304
    v_mfma_f32_16x16x32_bf16 v[56:59], v[108:111], v[124:127], v[56:59]
    ds_read_b64_tr_b16 v[146:147], v5 offset:11584
    v_mfma_f32_16x16x32_bf16 v[60:63], v[108:111], v[128:131], v[60:63]
    ds_read_b64_tr_b16 v[148:149], v5 offset:10336
    v_mfma_f32_16x16x32_bf16 v[64:67], v[108:111], v[132:135], v[64:67]
    ds_read_b64_tr_b16 v[150:151], v5 offset:11616
    v_mfma_f32_16x16x32_bf16 v[68:71], v[112:115], v[120:123], v[68:71]
    ds_read_b64_tr_b16 v[152:153], v6 offset:10368
    v_mfma_f32_16x16x32_bf16 v[72:75], v[112:115], v[124:127], v[72:75]
    ds_read_b64_tr_b16 v[154:155], v6 offset:11648
    v_mfma_f32_16x16x32_bf16 v[76:79], v[112:115], v[128:131], v[76:79]
    v_mfma_f32_16x16x32_bf16 v[80:83], v[112:115], v[132:135], v[80:83]
    v_mfma_f32_16x16x32_bf16 v[84:87], v[116:119], v[120:123], v[84:87]
    v_mfma_f32_16x16x32_bf16 v[88:91], v[116:119], v[124:127], v[88:91]
    v_mfma_f32_16x16x32_bf16 v[92:95], v[116:119], v[128:131], v[92:95]
    v_mfma_f32_16x16x32_bf16 v[96:99], v[116:119], v[132:135], v[96:99]
    s_waitcnt lgkmcnt(0)
    v_mfma_f32_16x16x32_bf16 v[20:23], v[136:139], v[156:159], v[20:23]
    ds_read_b128 v[120:123], v7
    v_mfma_f32_16x16x32_bf16 v[24:27], v[136:139], v[160:163], v[24:27]
    ds_read_b128 v[124:127], v7 offset:2048
    v_mfma_f32_16x16x32_bf16 v[28:31], v[136:139], v[164:167], v[28:31]
    ds_read_b128 v[128:131], v7 offset:4096
    v_mfma_f32_16x16x32_bf16 v[32:35], v[136:139], v[168:171], v[32:35]
    ds_read_b128 v[132:135], v7 offset:6144
    v_mfma_f32_16x16x32_bf16 v[36:39], v[140:143], v[156:159], v[36:39]
    ds_read_b64_tr_b16 v[100:101], v8
    v_mfma_f32_16x16x32_bf16 v[40:43], v[140:143], v[160:163], v[40:43]
    ds_read_b64_tr_b16 v[102:103], v8 offset:1280
    v_mfma_f32_16x16x32_bf16 v[44:47], v[140:143], v[164:167], v[44:47]
    ds_read_b64_tr_b16 v[104:105], v8 offset:32
    v_mfma_f32_16x16x32_bf16 v[48:51], v[140:143], v[168:171], v[48:51]
    ds_read_b64_tr_b16 v[106:107], v8 offset:1312
    v_mfma_f32_16x16x32_bf16 v[52:55], v[144:147], v[156:159], v[52:55]
    ds_read_b64_tr_b16 v[108:109], v8 offset:64
    v_mfma_f32_16x16x32_bf16 v[56:59], v[144:147], v[160:163], v[56:59]
    ds_read_b64_tr_b16 v[110:111], v8 offset:1344
    v_mfma_f32_16x16x32_bf16 v[60:63], v[144:147], v[164:167], v[60:63]
    ds_read_b64_tr_b16 v[112:113], v8 offset:96
    v_mfma_f32_16x16x32_bf16 v[64:67], v[144:147], v[168:171], v[64:67]
    ds_read_b64_tr_b16 v[114:115], v8 offset:1376
    v_mfma_f32_16x16x32_bf16 v[68:71], v[148:151], v[156:159], v[68:71]
    ds_read_b64_tr_b16 v[116:117], v9 offset:128
    v_mfma_f32_16x16x32_bf16 v[72:75], v[148:151], v[160:163], v[72:75]
    ds_read_b64_tr_b16 v[118:119], v9 offset:1408
    v_mfma_f32_16x16x32_bf16 v[76:79], v[148:151], v[164:167], v[76:79]
    v_mfma_f32_16x16x32_bf16 v[80:83], v[148:151], v[168:171], v[80:83]
    v_mfma_f32_16x16x32_bf16 v[84:87], v[152:155], v[156:159], v[84:87]
    v_mfma_f32_16x16x32_bf16 v[88:91], v[152:155], v[160:163], v[88:91]
    v_mfma_f32_16x16x32_bf16 v[92:95], v[152:155], v[164:167], v[92:95]
    v_mfma_f32_16x16x32_bf16 v[96:99], v[152:155], v[168:171], v[96:99]
    s_barrier
    s_waitcnt lgkmcnt(0)
    v_mfma_f32_16x16x32_bf16 v[20:23], v[100:103], v[120:123], v[20:23]
    ds_read_b128 v[156:159], v7 offset:1024
    v_mfma_f32_16x16x32_bf16 v[24:27], v[100:103], v[124:127], v[24:27]
    ds_read_b128 v[160:163], v7 offset:3072
    v_mfma_f32_16x16x32_bf16 v[28:31], v[100:103], v[128:131], v[28:31]
    ds_read_b128 v[164:167], v7 offset:5120
    v_mfma_f32_16x16x32_bf16 v[32:35], v[100:103], v[132:135], v[32:35]
    ds_read_b128 v[168:171], v7 offset:7168
    v_mfma_f32_16x16x32_bf16 v[36:39], v[104:107], v[120:123], v[36:39]
    ds_read_b64_tr_b16 v[136:137], v8 offset:10240
    v_mfma_f32_16x16x32_bf16 v[40:43], v[104:107], v[124:127], v[40:43]
    ds_read_b64_tr_b16 v[138:139], v8 offset:11520
    v_mfma_f32_16x16x32_bf16 v[44:47], v[104:107], v[128:131], v[44:47]
    ds_read_b64_tr_b16 v[140:141], v8 offset:10272
    v_mfma_f32_16x16x32_bf16 v[48:51], v[104:107], v[132:135], v[48:51]
    ds_read_b64_tr_b16 v[142:143], v8 offset:11552
    v_mfma_f32_16x16x32_bf16 v[52:55], v[108:111], v[120:123], v[52:55]
    ds_read_b64_tr_b16 v[144:145], v8 offset:10304
    v_mfma_f32_16x16x32_bf16 v[56:59], v[108:111], v[124:127], v[56:59]
    ds_read_b64_tr_b16 v[146:147], v8 offset:11584
    v_mfma_f32_16x16x32_bf16 v[60:63], v[108:111], v[128:131], v[60:63]
    ds_read_b64_tr_b16 v[148:149], v8 offset:10336
    v_mfma_f32_16x16x32_bf16 v[64:67], v[108:111], v[132:135], v[64:67]
    ds_read_b64_tr_b16 v[150:151], v8 offset:11616
    v_mfma_f32_16x16x32_bf16 v[68:71], v[112:115], v[120:123], v[68:71]
    ds_read_b64_tr_b16 v[152:153], v9 offset:10368
    v_mfma_f32_16x16x32_bf16 v[72:75], v[112:115], v[124:127], v[72:75]
    ds_read_b64_tr_b16 v[154:155], v9 offset:11648
    v_mfma_f32_16x16x32_bf16 v[76:79], v[112:115], v[128:131], v[76:79]
    v_mfma_f32_16x16x32_bf16 v[80:83], v[112:115], v[132:135], v[80:83]
    v_mfma_f32_16x16x32_bf16 v[84:87], v[116:119], v[120:123], v[84:87]
    v_mfma_f32_16x16x32_bf16 v[88:91], v[116:119], v[124:127], v[88:91]
    v_mfma_f32_16x16x32_bf16 v[92:95], v[116:119], v[128:131], v[92:95]
    v_mfma_f32_16x16x32_bf16 v[96:99], v[116:119], v[132:135], v[96:99]
    s_waitcnt lgkmcnt(0)
    v_mfma_f32_16x16x32_bf16 v[20:23], v[136:139], v[156:159], v[20:23]
    ds_read_b128 v[120:123], v10
    v_mfma_f32_16x16x32_bf16 v[24:27], v[136:139], v[160:163], v[24:27]
    ds_read_b128 v[124:127], v10 offset:2048
    v_mfma_f32_16x16x32_bf16 v[28:31], v[136:139], v[164:167], v[28:31]
    ds_read_b128 v[128:131], v10 offset:4096
    v_mfma_f32_16x16x32_bf16 v[32:35], v[136:139], v[168:171], v[32:35]
    ds_read_b128 v[132:135], v10 offset:6144
    v_mfma_f32_16x16x32_bf16 v[36:39], v[140:143], v[156:159], v[36:39]
    ds_read_b64_tr_b16 v[100:101], v11
    v_mfma_f32_16x16x32_bf16 v[40:43], v[140:143], v[160:163], v[40:43]
    ds_read_b64_tr_b16 v[102:103], v11 offset:1280
    v_mfma_f32_16x16x32_bf16 v[44:47], v[140:143], v[164:167], v[44:47]
    ds_read_b64_tr_b16 v[104:105], v11 offset:32
    v_mfma_f32_16x16x32_bf16 v[48:51], v[140:143], v[168:171], v[48:51]
    ds_read_b64_tr_b16 v[106:107], v11 offset:1312
    v_mfma_f32_16x16x32_bf16 v[52:55], v[144:147], v[156:159], v[52:55]
    ds_read_b64_tr_b16 v[108:109], v11 offset:64
    v_mfma_f32_16x16x32_bf16 v[56:59], v[144:147], v[160:163], v[56:59]
    ds_read_b64_tr_b16 v[110:111], v11 offset:1344
    v_mfma_f32_16x16x32_bf16 v[60:63], v[144:147], v[164:167], v[60:63]
    ds_read_b64_tr_b16 v[112:113], v11 offset:96
    v_mfma_f32_16x16x32_bf16 v[64:67], v[144:147], v[168:171], v[64:67]
    ds_read_b64_tr_b16 v[114:115], v11 offset:1376
    v_mfma_f32_16x16x32_bf16 v[68:71], v[148:151], v[156:159], v[68:71]
    ds_read_b64_tr_b16 v[116:117], v12 offset:128
    v_mfma_f32_16x16x32_bf16 v[72:75], v[148:151], v[160:163], v[72:75]
    ds_read_b64_tr_b16 v[118:119], v12 offset:1408
    v_mfma_f32_16x16x32_bf16 v[76:79], v[148:151], v[164:167], v[76:79]
    v_mfma_f32_16x16x32_bf16 v[80:83], v[148:151], v[168:171], v[80:83]
    v_mfma_f32_16x16x32_bf16 v[84:87], v[152:155], v[156:159], v[84:87]
    v_mfma_f32_16x16x32_bf16 v[88:91], v[152:155], v[160:163], v[88:91]
    v_mfma_f32_16x16x32_bf16 v[92:95], v[152:155], v[164:167], v[92:95]
    v_mfma_f32_16x16x32_bf16 v[96:99], v[152:155], v[168:171], v[96:99]
    s_barrier
    s_waitcnt lgkmcnt(0)
    v_mfma_f32_16x16x32_bf16 v[20:23], v[100:103], v[120:123], v[20:23]
    ds_read_b128 v[156:159], v10 offset:1024
    v_mfma_f32_16x16x32_bf16 v[24:27], v[100:103], v[124:127], v[24:27]
    ds_read_b128 v[160:163], v10 offset:3072
    v_mfma_f32_16x16x32_bf16 v[28:31], v[100:103], v[128:131], v[28:31]
    ds_read_b128 v[164:167], v10 offset:5120
    v_mfma_f32_16x16x32_bf16 v[32:35], v[100:103], v[132:135], v[32:35]
    ds_read_b128 v[168:171], v10 offset:7168
    v_mfma_f32_16x16x32_bf16 v[36:39], v[104:107], v[120:123], v[36:39]
    ds_read_b64_tr_b16 v[136:137], v11 offset:10240
    v_mfma_f32_16x16x32_bf16 v[40:43], v[104:107], v[124:127], v[40:43]
    ds_read_b64_tr_b16 v[138:139], v11 offset:11520
    v_mfma_f32_16x16x32_bf16 v[44:47], v[104:107], v[128:131], v[44:47]
    ds_read_b64_tr_b16 v[140:141], v11 offset:10272
    v_mfma_f32_16x16x32_bf16 v[48:51], v[104:107], v[132:135], v[48:51]
    ds_read_b64_tr_b16 v[142:143], v11 offset:11552
    v_mfma_f32_16x16x32_bf16 v[52:55], v[108:111], v[120:123], v[52:55]
    ds_read_b64_tr_b16 v[144:145], v11 offset:10304
    v_mfma_f32_16x16x32_bf16 v[56:59], v[108:111], v[124:127], v[56:59]
    ds_read_b64_tr_b16 v[146:147], v11 offset:11584
    v_mfma_f32_16x16x32_bf16 v[60:63], v[108:111], v[128:131], v[60:63]
    ds_read_b64_tr_b16 v[148:149], v11 offset:10336
    v_mfma_f32_16x16x32_bf16 v[64:67], v[108:111], v[132:135], v[64:67]
    ds_read_b64_tr_b16 v[150:151], v11 offset:11616
    v_mfma_f32_16x16x32_bf16 v[68:71], v[112:115], v[120:123], v[68:71]
    ds_read_b64_tr_b16 v[152:153], v12 offset:10368
    v_mfma_f32_16x16x32_bf16 v[72:75], v[112:115], v[124:127], v[72:75]
    ds_read_b64_tr_b16 v[154:155], v12 offset:11648
    v_mfma_f32_16x16x32_bf16 v[76:79], v[112:115], v[128:131], v[76:79]
    v_mfma_f32_16x16x32_bf16 v[80:83], v[112:115], v[132:135], v[80:83]
    v_mfma_f32_16x16x32_bf16 v[84:87], v[116:119], v[120:123], v[84:87]
    v_mfma_f32_16x16x32_bf16 v[88:91], v[116:119], v[124:127], v[88:91]
    v_mfma_f32_16x16x32_bf16 v[92:95], v[116:119], v[128:131], v[92:95]
    v_mfma_f32_16x16x32_bf16 v[96:99], v[116:119], v[132:135], v[96:99]
    s_waitcnt lgkmcnt(0)
    v_mfma_f32_16x16x32_bf16 v[20:23], v[136:139], v[156:159], v[20:23]
    ds_read_b128 v[120:123], v13
    v_mfma_f32_16x16x32_bf16 v[24:27], v[136:139], v[160:163], v[24:27]
    ds_read_b128 v[124:127], v13 offset:2048
    v_mfma_f32_16x16x32_bf16 v[28:31], v[136:139], v[164:167], v[28:31]
    ds_read_b128 v[128:131], v13 offset:4096
    v_mfma_f32_16x16x32_bf16 v[32:35], v[136:139], v[168:171], v[32:35]
    ds_read_b128 v[132:135], v13 offset:6144
    v_mfma_f32_16x16x32_bf16 v[36:39], v[140:143], v[156:159], v[36:39]
    ds_read_b64_tr_b16 v[100:101], v14
    v_mfma_f32_16x16x32_bf16 v[40:43], v[140:143], v[160:163], v[40:43]
    ds_read_b64_tr_b16 v[102:103], v14 offset:1280
    v_mfma_f32_16x16x32_bf16 v[44:47], v[140:143], v[164:167], v[44:47]
    ds_read_b64_tr_b16 v[104:105], v14 offset:32
    v_mfma_f32_16x16x32_bf16 v[48:51], v[140:143], v[168:171], v[48:51]
    ds_read_b64_tr_b16 v[106:107], v14 offset:1312
    v_mfma_f32_16x16x32_bf16 v[52:55], v[144:147], v[156:159], v[52:55]
    ds_read_b64_tr_b16 v[108:109], v14 offset:64
    v_mfma_f32_16x16x32_bf16 v[56:59], v[144:147], v[160:163], v[56:59]
    ds_read_b64_tr_b16 v[110:111], v14 offset:1344
    v_mfma_f32_16x16x32_bf16 v[60:63], v[144:147], v[164:167], v[60:63]
    ds_read_b64_tr_b16 v[112:113], v14 offset:96
    v_mfma_f32_16x16x32_bf16 v[64:67], v[144:147], v[168:171], v[64:67]
    ds_read_b64_tr_b16 v[114:115], v14 offset:1376
    v_mfma_f32_16x16x32_bf16 v[68:71], v[148:151], v[156:159], v[68:71]
    ds_read_b64_tr_b16 v[116:117], v15 offset:128
    v_mfma_f32_16x16x32_bf16 v[72:75], v[148:151], v[160:163], v[72:75]
    ds_read_b64_tr_b16 v[118:119], v15 offset:1408
    v_mfma_f32_16x16x32_bf16 v[76:79], v[148:151], v[164:167], v[76:79]
    v_mfma_f32_16x16x32_bf16 v[80:83], v[148:151], v[168:171], v[80:83]
    v_mfma_f32_16x16x32_bf16 v[84:87], v[152:155], v[156:159], v[84:87]
    v_mfma_f32_16x16x32_bf16 v[88:91], v[152:155], v[160:163], v[88:91]
    v_mfma_f32_16x16x32_bf16 v[92:95], v[152:155], v[164:167], v[92:95]
    v_mfma_f32_16x16x32_bf16 v[96:99], v[152:155], v[168:171], v[96:99]
    s_barrier
    s_waitcnt lgkmcnt(0)
    v_mfma_f32_16x16x32_bf16 v[20:23], v[100:103], v[120:123], v[20:23]
    ds_read_b128 v[156:159], v13 offset:1024
    v_mfma_f32_16x16x32_bf16 v[24:27], v[100:103], v[124:127], v[24:27]
    ds_read_b128 v[160:163], v13 offset:3072
    v_mfma_f32_16x16x32_bf16 v[28:31], v[100:103], v[128:131], v[28:31]
    ds_read_b128 v[164:167], v13 offset:5120
    v_mfma_f32_16x16x32_bf16 v[32:35], v[100:103], v[132:135], v[32:35]
    ds_read_b128 v[168:171], v13 offset:7168
    v_mfma_f32_16x16x32_bf16 v[36:39], v[104:107], v[120:123], v[36:39]
    ds_read_b64_tr_b16 v[136:137], v14 offset:10240
    v_mfma_f32_16x16x32_bf16 v[40:43], v[104:107], v[124:127], v[40:43]
    ds_read_b64_tr_b16 v[138:139], v14 offset:11520
    v_mfma_f32_16x16x32_bf16 v[44:47], v[104:107], v[128:131], v[44:47]
    ds_read_b64_tr_b16 v[140:141], v14 offset:10272
    v_mfma_f32_16x16x32_bf16 v[48:51], v[104:107], v[132:135], v[48:51]
    ds_read_b64_tr_b16 v[142:143], v14 offset:11552
    v_mfma_f32_16x16x32_bf16 v[52:55], v[108:111], v[120:123], v[52:55]
    ds_read_b64_tr_b16 v[144:145], v14 offset:10304
    v_mfma_f32_16x16x32_bf16 v[56:59], v[108:111], v[124:127], v[56:59]
    ds_read_b64_tr_b16 v[146:147], v14 offset:11584
    v_mfma_f32_16x16x32_bf16 v[60:63], v[108:111], v[128:131], v[60:63]
    ds_read_b64_tr_b16 v[148:149], v14 offset:10336
    v_mfma_f32_16x16x32_bf16 v[64:67], v[108:111], v[132:135], v[64:67]
    ds_read_b64_tr_b16 v[150:151], v14 offset:11616
    v_mfma_f32_16x16x32_bf16 v[68:71], v[112:115], v[120:123], v[68:71]
    ds_read_b64_tr_b16 v[152:153], v15 offset:10368
    v_mfma_f32_16x16x32_bf16 v[72:75], v[112:115], v[124:127], v[72:75]
    ds_read_b64_tr_b16 v[154:155], v15 offset:11648
    v_mfma_f32_16x16x32_bf16 v[76:79], v[112:115], v[128:131], v[76:79]
    v_mfma_f32_16x16x32_bf16 v[80:83], v[112:115], v[132:135], v[80:83]
    v_mfma_f32_16x16x32_bf16 v[84:87], v[116:119], v[120:123], v[84:87]
    v_mfma_f32_16x16x32_bf16 v[88:91], v[116:119], v[124:127], v[88:91]
    v_mfma_f32_16x16x32_bf16 v[92:95], v[116:119], v[128:131], v[92:95]
    v_mfma_f32_16x16x32_bf16 v[96:99], v[116:119], v[132:135], v[96:99]
    s_waitcnt lgkmcnt(0)
    v_mfma_f32_16x16x32_bf16 v[20:23], v[136:139], v[156:159], v[20:23]
    ds_read_b128 v[120:123], v4
    v_mfma_f32_16x16x32_bf16 v[24:27], v[136:139], v[160:163], v[24:27]
    ds_read_b128 v[124:127], v4 offset:2048
    v_mfma_f32_16x16x32_bf16 v[28:31], v[136:139], v[164:167], v[28:31]
    ds_read_b128 v[128:131], v4 offset:4096
    v_mfma_f32_16x16x32_bf16 v[32:35], v[136:139], v[168:171], v[32:35]
    ds_read_b128 v[132:135], v4 offset:6144
    v_mfma_f32_16x16x32_bf16 v[36:39], v[140:143], v[156:159], v[36:39]
    ds_read_b64_tr_b16 v[100:101], v5
    v_mfma_f32_16x16x32_bf16 v[40:43], v[140:143], v[160:163], v[40:43]
    ds_read_b64_tr_b16 v[102:103], v5 offset:1280
    v_mfma_f32_16x16x32_bf16 v[44:47], v[140:143], v[164:167], v[44:47]
    ds_read_b64_tr_b16 v[104:105], v5 offset:32
    v_mfma_f32_16x16x32_bf16 v[48:51], v[140:143], v[168:171], v[48:51]
    ds_read_b64_tr_b16 v[106:107], v5 offset:1312
    v_mfma_f32_16x16x32_bf16 v[52:55], v[144:147], v[156:159], v[52:55]
    ds_read_b64_tr_b16 v[108:109], v5 offset:64
    v_mfma_f32_16x16x32_bf16 v[56:59], v[144:147], v[160:163], v[56:59]
    ds_read_b64_tr_b16 v[110:111], v5 offset:1344
    v_mfma_f32_16x16x32_bf16 v[60:63], v[144:147], v[164:167], v[60:63]
    ds_read_b64_tr_b16 v[112:113], v5 offset:96
    v_mfma_f32_16x16x32_bf16 v[64:67], v[144:147], v[168:171], v[64:67]
    ds_read_b64_tr_b16 v[114:115], v5 offset:1376
    v_mfma_f32_16x16x32_bf16 v[68:71], v[148:151], v[156:159], v[68:71]
    ds_read_b64_tr_b16 v[116:117], v6 offset:128
    v_mfma_f32_16x16x32_bf16 v[72:75], v[148:151], v[160:163], v[72:75]
    ds_read_b64_tr_b16 v[118:119], v6 offset:1408
    v_mfma_f32_16x16x32_bf16 v[76:79], v[148:151], v[164:167], v[76:79]
    v_mfma_f32_16x16x32_bf16 v[80:83], v[148:151], v[168:171], v[80:83]
    v_mfma_f32_16x16x32_bf16 v[84:87], v[152:155], v[156:159], v[84:87]
    v_mfma_f32_16x16x32_bf16 v[88:91], v[152:155], v[160:163], v[88:91]
    v_mfma_f32_16x16x32_bf16 v[92:95], v[152:155], v[164:167], v[92:95]
    v_mfma_f32_16x16x32_bf16 v[96:99], v[152:155], v[168:171], v[96:99]
    s_barrier
    s_waitcnt lgkmcnt(0)
    v_mfma_f32_16x16x32_bf16 v[20:23], v[100:103], v[120:123], v[20:23]
    ds_read_b128 v[156:159], v4 offset:1024
    v_mfma_f32_16x16x32_bf16 v[24:27], v[100:103], v[124:127], v[24:27]
    ds_read_b128 v[160:163], v4 offset:3072
    v_mfma_f32_16x16x32_bf16 v[28:31], v[100:103], v[128:131], v[28:31]
    ds_read_b128 v[164:167], v4 offset:5120
    v_mfma_f32_16x16x32_bf16 v[32:35], v[100:103], v[132:135], v[32:35]
    ds_read_b128 v[168:171], v4 offset:7168
    v_mfma_f32_16x16x32_bf16 v[36:39], v[104:107], v[120:123], v[36:39]
    ds_read_b64_tr_b16 v[136:137], v5 offset:10240
    v_mfma_f32_16x16x32_bf16 v[40:43], v[104:107], v[124:127], v[40:43]
    ds_read_b64_tr_b16 v[138:139], v5 offset:11520
    v_mfma_f32_16x16x32_bf16 v[44:47], v[104:107], v[128:131], v[44:47]
    ds_read_b64_tr_b16 v[140:141], v5 offset:10272
    v_mfma_f32_16x16x32_bf16 v[48:51], v[104:107], v[132:135], v[48:51]
    ds_read_b64_tr_b16 v[142:143], v5 offset:11552
    v_mfma_f32_16x16x32_bf16 v[52:55], v[108:111], v[120:123], v[52:55]
    ds_read_b64_tr_b16 v[144:145], v5 offset:10304
    v_mfma_f32_16x16x32_bf16 v[56:59], v[108:111], v[124:127], v[56:59]
    ds_read_b64_tr_b16 v[146:147], v5 offset:11584
    v_mfma_f32_16x16x32_bf16 v[60:63], v[108:111], v[128:131], v[60:63]
    ds_read_b64_tr_b16 v[148:149], v5 offset:10336
    v_mfma_f32_16x16x32_bf16 v[64:67], v[108:111], v[132:135], v[64:67]
    ds_read_b64_tr_b16 v[150:151], v5 offset:11616
    v_mfma_f32_16x16x32_bf16 v[68:71], v[112:115], v[120:123], v[68:71]
    ds_read_b64_tr_b16 v[152:153], v6 offset:10368
    v_mfma_f32_16x16x32_bf16 v[72:75], v[112:115], v[124:127], v[72:75]
    ds_read_b64_tr_b16 v[154:155], v6 offset:11648
    v_mfma_f32_16x16x32_bf16 v[76:79], v[112:115], v[128:131], v[76:79]
    v_mfma_f32_16x16x32_bf16 v[80:83], v[112:115], v[132:135], v[80:83]
    v_mfma_f32_16x16x32_bf16 v[84:87], v[116:119], v[120:123], v[84:87]
    v_mfma_f32_16x16x32_bf16 v[88:91], v[116:119], v[124:127], v[88:91]
    v_mfma_f32_16x16x32_bf16 v[92:95], v[116:119], v[128:131], v[92:95]
    v_mfma_f32_16x16x32_bf16 v[96:99], v[116:119], v[132:135], v[96:99]
    s_waitcnt lgkmcnt(0)
    v_mfma_f32_16x16x32_bf16 v[20:23], v[136:139], v[156:159], v[20:23]
    ds_read_b128 v[120:123], v7
    v_mfma_f32_16x16x32_bf16 v[24:27], v[136:139], v[160:163], v[24:27]
    ds_read_b128 v[124:127], v7 offset:2048
    v_mfma_f32_16x16x32_bf16 v[28:31], v[136:139], v[164:167], v[28:31]
    ds_read_b128 v[128:131], v7 offset:4096
    v_mfma_f32_16x16x32_bf16 v[32:35], v[136:139], v[168:171], v[32:35]
    ds_read_b128 v[132:135], v7 offset:6144
    v_mfma_f32_16x16x32_bf16 v[36:39], v[140:143], v[156:159], v[36:39]
    ds_read_b64_tr_b16 v[100:101], v8
    v_mfma_f32_16x16x32_bf16 v[40:43], v[140:143], v[160:163], v[40:43]
    ds_read_b64_tr_b16 v[102:103], v8 offset:1280
    v_mfma_f32_16x16x32_bf16 v[44:47], v[140:143], v[164:167], v[44:47]
    ds_read_b64_tr_b16 v[104:105], v8 offset:32
    v_mfma_f32_16x16x32_bf16 v[48:51], v[140:143], v[168:171], v[48:51]
    ds_read_b64_tr_b16 v[106:107], v8 offset:1312
    v_mfma_f32_16x16x32_bf16 v[52:55], v[144:147], v[156:159], v[52:55]
    ds_read_b64_tr_b16 v[108:109], v8 offset:64
    v_mfma_f32_16x16x32_bf16 v[56:59], v[144:147], v[160:163], v[56:59]
    ds_read_b64_tr_b16 v[110:111], v8 offset:1344
    v_mfma_f32_16x16x32_bf16 v[60:63], v[144:147], v[164:167], v[60:63]
    ds_read_b64_tr_b16 v[112:113], v8 offset:96
    v_mfma_f32_16x16x32_bf16 v[64:67], v[144:147], v[168:171], v[64:67]
    ds_read_b64_tr_b16 v[114:115], v8 offset:1376
    v_mfma_f32_16x16x32_bf16 v[68:71], v[148:151], v[156:159], v[68:71]
    ds_read_b64_tr_b16 v[116:117], v9 offset:128
    v_mfma_f32_16x16x32_bf16 v[72:75], v[148:151], v[160:163], v[72:75]
    ds_read_b64_tr_b16 v[118:119], v9 offset:1408
    v_mfma_f32_16x16x32_bf16 v[76:79], v[148:151], v[164:167], v[76:79]
    v_mfma_f32_16x16x32_bf16 v[80:83], v[148:151], v[168:171], v[80:83]
    v_mfma_f32_16x16x32_bf16 v[84:87], v[152:155], v[156:159], v[84:87]
    v_mfma_f32_16x16x32_bf16 v[88:91], v[152:155], v[160:163], v[88:91]
    v_mfma_f32_16x16x32_bf16 v[92:95], v[152:155], v[164:167], v[92:95]
    v_mfma_f32_16x16x32_bf16 v[96:99], v[152:155], v[168:171], v[96:99]
    s_barrier
    s_waitcnt lgkmcnt(0)
    v_mfma_f32_16x16x32_bf16 v[20:23], v[100:103], v[120:123], v[20:23]
    ds_read_b128 v[156:159], v7 offset:1024
    v_mfma_f32_16x16x32_bf16 v[24:27], v[100:103], v[124:127], v[24:27]
    ds_read_b128 v[160:163], v7 offset:3072
    v_mfma_f32_16x16x32_bf16 v[28:31], v[100:103], v[128:131], v[28:31]
    ds_read_b128 v[164:167], v7 offset:5120
    v_mfma_f32_16x16x32_bf16 v[32:35], v[100:103], v[132:135], v[32:35]
    ds_read_b128 v[168:171], v7 offset:7168
    v_mfma_f32_16x16x32_bf16 v[36:39], v[104:107], v[120:123], v[36:39]
    ds_read_b64_tr_b16 v[136:137], v8 offset:10240
    v_mfma_f32_16x16x32_bf16 v[40:43], v[104:107], v[124:127], v[40:43]
    ds_read_b64_tr_b16 v[138:139], v8 offset:11520
    v_mfma_f32_16x16x32_bf16 v[44:47], v[104:107], v[128:131], v[44:47]
    ds_read_b64_tr_b16 v[140:141], v8 offset:10272
    v_mfma_f32_16x16x32_bf16 v[48:51], v[104:107], v[132:135], v[48:51]
    ds_read_b64_tr_b16 v[142:143], v8 offset:11552
    v_mfma_f32_16x16x32_bf16 v[52:55], v[108:111], v[120:123], v[52:55]
    ds_read_b64_tr_b16 v[144:145], v8 offset:10304
    v_mfma_f32_16x16x32_bf16 v[56:59], v[108:111], v[124:127], v[56:59]
    ds_read_b64_tr_b16 v[146:147], v8 offset:11584
    v_mfma_f32_16x16x32_bf16 v[60:63], v[108:111], v[128:131], v[60:63]
    ds_read_b64_tr_b16 v[148:149], v8 offset:10336
    v_mfma_f32_16x16x32_bf16 v[64:67], v[108:111], v[132:135], v[64:67]
    ds_read_b64_tr_b16 v[150:151], v8 offset:11616
    v_mfma_f32_16x16x32_bf16 v[68:71], v[112:115], v[120:123], v[68:71]
    ds_read_b64_tr_b16 v[152:153], v9 offset:10368
    v_mfma_f32_16x16x32_bf16 v[72:75], v[112:115], v[124:127], v[72:75]
    ds_read_b64_tr_b16 v[154:155], v9 offset:11648
    v_mfma_f32_16x16x32_bf16 v[76:79], v[112:115], v[128:131], v[76:79]
    v_mfma_f32_16x16x32_bf16 v[80:83], v[112:115], v[132:135], v[80:83]
    v_mfma_f32_16x16x32_bf16 v[84:87], v[116:119], v[120:123], v[84:87]
    v_mfma_f32_16x16x32_bf16 v[88:91], v[116:119], v[124:127], v[88:91]
    v_mfma_f32_16x16x32_bf16 v[92:95], v[116:119], v[128:131], v[92:95]
    v_mfma_f32_16x16x32_bf16 v[96:99], v[116:119], v[132:135], v[96:99]
    s_waitcnt lgkmcnt(0)
    v_mfma_f32_16x16x32_bf16 v[20:23], v[136:139], v[156:159], v[20:23]
    ds_read_b128 v[120:123], v10
    v_mfma_f32_16x16x32_bf16 v[24:27], v[136:139], v[160:163], v[24:27]
    ds_read_b128 v[124:127], v10 offset:2048
    v_mfma_f32_16x16x32_bf16 v[28:31], v[136:139], v[164:167], v[28:31]
    ds_read_b128 v[128:131], v10 offset:4096
    v_mfma_f32_16x16x32_bf16 v[32:35], v[136:139], v[168:171], v[32:35]
    ds_read_b128 v[132:135], v10 offset:6144
    v_mfma_f32_16x16x32_bf16 v[36:39], v[140:143], v[156:159], v[36:39]
    ds_read_b64_tr_b16 v[100:101], v11
    v_mfma_f32_16x16x32_bf16 v[40:43], v[140:143], v[160:163], v[40:43]
    ds_read_b64_tr_b16 v[102:103], v11 offset:1280
    v_mfma_f32_16x16x32_bf16 v[44:47], v[140:143], v[164:167], v[44:47]
    ds_read_b64_tr_b16 v[104:105], v11 offset:32
    v_mfma_f32_16x16x32_bf16 v[48:51], v[140:143], v[168:171], v[48:51]
    ds_read_b64_tr_b16 v[106:107], v11 offset:1312
    v_mfma_f32_16x16x32_bf16 v[52:55], v[144:147], v[156:159], v[52:55]
    ds_read_b64_tr_b16 v[108:109], v11 offset:64
    v_mfma_f32_16x16x32_bf16 v[56:59], v[144:147], v[160:163], v[56:59]
    ds_read_b64_tr_b16 v[110:111], v11 offset:1344
    v_mfma_f32_16x16x32_bf16 v[60:63], v[144:147], v[164:167], v[60:63]
    ds_read_b64_tr_b16 v[112:113], v11 offset:96
    v_mfma_f32_16x16x32_bf16 v[64:67], v[144:147], v[168:171], v[64:67]
    ds_read_b64_tr_b16 v[114:115], v11 offset:1376
    v_mfma_f32_16x16x32_bf16 v[68:71], v[148:151], v[156:159], v[68:71]
    ds_read_b64_tr_b16 v[116:117], v12 offset:128
    v_mfma_f32_16x16x32_bf16 v[72:75], v[148:151], v[160:163], v[72:75]
    ds_read_b64_tr_b16 v[118:119], v12 offset:1408
    v_mfma_f32_16x16x32_bf16 v[76:79], v[148:151], v[164:167], v[76:79]
    v_mfma_f32_16x16x32_bf16 v[80:83], v[148:151], v[168:171], v[80:83]
    v_mfma_f32_16x16x32_bf16 v[84:87], v[152:155], v[156:159], v[84:87]
    v_mfma_f32_16x16x32_bf16 v[88:91], v[152:155], v[160:163], v[88:91]
    v_mfma_f32_16x16x32_bf16 v[92:95], v[152:155], v[164:167], v[92:95]
    v_mfma_f32_16x16x32_bf16 v[96:99], v[152:155], v[168:171], v[96:99]
    s_barrier
    s_waitcnt lgkmcnt(0)
    v_mfma_f32_16x16x32_bf16 v[20:23], v[100:103], v[120:123], v[20:23]
    ds_read_b128 v[156:159], v10 offset:1024
    v_mfma_f32_16x16x32_bf16 v[24:27], v[100:103], v[124:127], v[24:27]
    ds_read_b128 v[160:163], v10 offset:3072
    v_mfma_f32_16x16x32_bf16 v[28:31], v[100:103], v[128:131], v[28:31]
    ds_read_b128 v[164:167], v10 offset:5120
    v_mfma_f32_16x16x32_bf16 v[32:35], v[100:103], v[132:135], v[32:35]
    ds_read_b128 v[168:171], v10 offset:7168
    v_mfma_f32_16x16x32_bf16 v[36:39], v[104:107], v[120:123], v[36:39]
    ds_read_b64_tr_b16 v[136:137], v11 offset:10240
    v_mfma_f32_16x16x32_bf16 v[40:43], v[104:107], v[124:127], v[40:43]
    ds_read_b64_tr_b16 v[138:139], v11 offset:11520
    v_mfma_f32_16x16x32_bf16 v[44:47], v[104:107], v[128:131], v[44:47]
    ds_read_b64_tr_b16 v[140:141], v11 offset:10272
    v_mfma_f32_16x16x32_bf16 v[48:51], v[104:107], v[132:135], v[48:51]
    ds_read_b64_tr_b16 v[142:143], v11 offset:11552
    v_mfma_f32_16x16x32_bf16 v[52:55], v[108:111], v[120:123], v[52:55]
    ds_read_b64_tr_b16 v[144:145], v11 offset:10304
    v_mfma_f32_16x16x32_bf16 v[56:59], v[108:111], v[124:127], v[56:59]
    ds_read_b64_tr_b16 v[146:147], v11 offset:11584
    v_mfma_f32_16x16x32_bf16 v[60:63], v[108:111], v[128:131], v[60:63]
    ds_read_b64_tr_b16 v[148:149], v11 offset:10336
    v_mfma_f32_16x16x32_bf16 v[64:67], v[108:111], v[132:135], v[64:67]
    ds_read_b64_tr_b16 v[150:151], v11 offset:11616
    v_mfma_f32_16x16x32_bf16 v[68:71], v[112:115], v[120:123], v[68:71]
    ds_read_b64_tr_b16 v[152:153], v12 offset:10368
    v_mfma_f32_16x16x32_bf16 v[72:75], v[112:115], v[124:127], v[72:75]
    ds_read_b64_tr_b16 v[154:155], v12 offset:11648
    v_mfma_f32_16x16x32_bf16 v[76:79], v[112:115], v[128:131], v[76:79]
    v_mfma_f32_16x16x32_bf16 v[80:83], v[112:115], v[132:135], v[80:83]
    v_mfma_f32_16x16x32_bf16 v[84:87], v[116:119], v[120:123], v[84:87]
    v_mfma_f32_16x16x32_bf16 v[88:91], v[116:119], v[124:127], v[88:91]
    v_mfma_f32_16x16x32_bf16 v[92:95], v[116:119], v[128:131], v[92:95]
    v_mfma_f32_16x16x32_bf16 v[96:99], v[116:119], v[132:135], v[96:99]
    s_waitcnt lgkmcnt(0)
    v_mfma_f32_16x16x32_bf16 v[20:23], v[136:139], v[156:159], v[20:23]
    ds_read_b128 v[120:123], v13
    v_mfma_f32_16x16x32_bf16 v[24:27], v[136:139], v[160:163], v[24:27]
    ds_read_b128 v[124:127], v13 offset:2048
    v_mfma_f32_16x16x32_bf16 v[28:31], v[136:139], v[164:167], v[28:31]
    ds_read_b128 v[128:131], v13 offset:4096
    v_mfma_f32_16x16x32_bf16 v[32:35], v[136:139], v[168:171], v[32:35]
    ds_read_b128 v[132:135], v13 offset:6144
    v_mfma_f32_16x16x32_bf16 v[36:39], v[140:143], v[156:159], v[36:39]
    ds_read_b64_tr_b16 v[100:101], v14
    v_mfma_f32_16x16x32_bf16 v[40:43], v[140:143], v[160:163], v[40:43]
    ds_read_b64_tr_b16 v[102:103], v14 offset:1280
    v_mfma_f32_16x16x32_bf16 v[44:47], v[140:143], v[164:167], v[44:47]
    ds_read_b64_tr_b16 v[104:105], v14 offset:32
    v_mfma_f32_16x16x32_bf16 v[48:51], v[140:143], v[168:171], v[48:51]
    ds_read_b64_tr_b16 v[106:107], v14 offset:1312
    v_mfma_f32_16x16x32_bf16 v[52:55], v[144:147], v[156:159], v[52:55]
    ds_read_b64_tr_b16 v[108:109], v14 offset:64
    v_mfma_f32_16x16x32_bf16 v[56:59], v[144:147], v[160:163], v[56:59]
    ds_read_b64_tr_b16 v[110:111], v14 offset:1344
    v_mfma_f32_16x16x32_bf16 v[60:63], v[144:147], v[164:167], v[60:63]
    ds_read_b64_tr_b16 v[112:113], v14 offset:96
    v_mfma_f32_16x16x32_bf16 v[64:67], v[144:147], v[168:171], v[64:67]
    ds_read_b64_tr_b16 v[114:115], v14 offset:1376
    v_mfma_f32_16x16x32_bf16 v[68:71], v[148:151], v[156:159], v[68:71]
    ds_read_b64_tr_b16 v[116:117], v15 offset:128
    v_mfma_f32_16x16x32_bf16 v[72:75], v[148:151], v[160:163], v[72:75]
    ds_read_b64_tr_b16 v[118:119], v15 offset:1408
    v_mfma_f32_16x16x32_bf16 v[76:79], v[148:151], v[164:167], v[76:79]
    v_mfma_f32_16x16x32_bf16 v[80:83], v[148:151], v[168:171], v[80:83]
    v_mfma_f32_16x16x32_bf16 v[84:87], v[152:155], v[156:159], v[84:87]
    v_mfma_f32_16x16x32_bf16 v[88:91], v[152:155], v[160:163], v[88:91]
    v_mfma_f32_16x16x32_bf16 v[92:95], v[152:155], v[164:167], v[92:95]
    v_mfma_f32_16x16x32_bf16 v[96:99], v[152:155], v[168:171], v[96:99]
    s_barrier
    s_waitcnt lgkmcnt(0)
    v_mfma_f32_16x16x32_bf16 v[20:23], v[100:103], v[120:123], v[20:23]
    ds_read_b128 v[156:159], v13 offset:1024
    v_mfma_f32_16x16x32_bf16 v[24:27], v[100:103], v[124:127], v[24:27]
    ds_read_b128 v[160:163], v13 offset:3072
    v_mfma_f32_16x16x32_bf16 v[28:31], v[100:103], v[128:131], v[28:31]
    ds_read_b128 v[164:167], v13 offset:5120
    v_mfma_f32_16x16x32_bf16 v[32:35], v[100:103], v[132:135], v[32:35]
    ds_read_b128 v[168:171], v13 offset:7168
    v_mfma_f32_16x16x32_bf16 v[36:39], v[104:107], v[120:123], v[36:39]
    ds_read_b64_tr_b16 v[136:137], v14 offset:10240
    v_mfma_f32_16x16x32_bf16 v[40:43], v[104:107], v[124:127], v[40:43]
    ds_read_b64_tr_b16 v[138:139], v14 offset:11520
    v_mfma_f32_16x16x32_bf16 v[44:47], v[104:107], v[128:131], v[44:47]
    ds_read_b64_tr_b16 v[140:141], v14 offset:10272
    v_mfma_f32_16x16x32_bf16 v[48:51], v[104:107], v[132:135], v[48:51]
    ds_read_b64_tr_b16 v[142:143], v14 offset:11552
    v_mfma_f32_16x16x32_bf16 v[52:55], v[108:111], v[120:123], v[52:55]
    ds_read_b64_tr_b16 v[144:145], v14 offset:10304
    v_mfma_f32_16x16x32_bf16 v[56:59], v[108:111], v[124:127], v[56:59]
    ds_read_b64_tr_b16 v[146:147], v14 offset:11584
    v_mfma_f32_16x16x32_bf16 v[60:63], v[108:111], v[128:131], v[60:63]
    ds_read_b64_tr_b16 v[148:149], v14 offset:10336
    v_mfma_f32_16x16x32_bf16 v[64:67], v[108:111], v[132:135], v[64:67]
    ds_read_b64_tr_b16 v[150:151], v14 offset:11616
    v_mfma_f32_16x16x32_bf16 v[68:71], v[112:115], v[120:123], v[68:71]
    ds_read_b64_tr_b16 v[152:153], v15 offset:10368
    v_mfma_f32_16x16x32_bf16 v[72:75], v[112:115], v[124:127], v[72:75]
    ds_read_b64_tr_b16 v[154:155], v15 offset:11648
    v_mfma_f32_16x16x32_bf16 v[76:79], v[112:115], v[128:131], v[76:79]
    v_mfma_f32_16x16x32_bf16 v[80:83], v[112:115], v[132:135], v[80:83]
    v_mfma_f32_16x16x32_bf16 v[84:87], v[116:119], v[120:123], v[84:87]
    v_mfma_f32_16x16x32_bf16 v[88:91], v[116:119], v[124:127], v[88:91]
    v_mfma_f32_16x16x32_bf16 v[92:95], v[116:119], v[128:131], v[92:95]
    v_mfma_f32_16x16x32_bf16 v[96:99], v[116:119], v[132:135], v[96:99]
    s_waitcnt lgkmcnt(0)
    v_mfma_f32_16x16x32_bf16 v[20:23], v[136:139], v[156:159], v[20:23]
    ds_read_b128 v[120:123], v4
    v_mfma_f32_16x16x32_bf16 v[24:27], v[136:139], v[160:163], v[24:27]
    ds_read_b128 v[124:127], v4 offset:2048
    v_mfma_f32_16x16x32_bf16 v[28:31], v[136:139], v[164:167], v[28:31]
    ds_read_b128 v[128:131], v4 offset:4096
    v_mfma_f32_16x16x32_bf16 v[32:35], v[136:139], v[168:171], v[32:35]
    ds_read_b128 v[132:135], v4 offset:6144
    v_mfma_f32_16x16x32_bf16 v[36:39], v[140:143], v[156:159], v[36:39]
    ds_read_b64_tr_b16 v[100:101], v5
    v_mfma_f32_16x16x32_bf16 v[40:43], v[140:143], v[160:163], v[40:43]
    ds_read_b64_tr_b16 v[102:103], v5 offset:1280
    v_mfma_f32_16x16x32_bf16 v[44:47], v[140:143], v[164:167], v[44:47]
    ds_read_b64_tr_b16 v[104:105], v5 offset:32
    v_mfma_f32_16x16x32_bf16 v[48:51], v[140:143], v[168:171], v[48:51]
    ds_read_b64_tr_b16 v[106:107], v5 offset:1312
    v_mfma_f32_16x16x32_bf16 v[52:55], v[144:147], v[156:159], v[52:55]
    ds_read_b64_tr_b16 v[108:109], v5 offset:64
    v_mfma_f32_16x16x32_bf16 v[56:59], v[144:147], v[160:163], v[56:59]
    ds_read_b64_tr_b16 v[110:111], v5 offset:1344
    v_mfma_f32_16x16x32_bf16 v[60:63], v[144:147], v[164:167], v[60:63]
    ds_read_b64_tr_b16 v[112:113], v5 offset:96
    v_mfma_f32_16x16x32_bf16 v[64:67], v[144:147], v[168:171], v[64:67]
    ds_read_b64_tr_b16 v[114:115], v5 offset:1376
    v_mfma_f32_16x16x32_bf16 v[68:71], v[148:151], v[156:159], v[68:71]
    ds_read_b64_tr_b16 v[116:117], v6 offset:128
    v_mfma_f32_16x16x32_bf16 v[72:75], v[148:151], v[160:163], v[72:75]
    ds_read_b64_tr_b16 v[118:119], v6 offset:1408
    v_mfma_f32_16x16x32_bf16 v[76:79], v[148:151], v[164:167], v[76:79]
    v_mfma_f32_16x16x32_bf16 v[80:83], v[148:151], v[168:171], v[80:83]
    v_mfma_f32_16x16x32_bf16 v[84:87], v[152:155], v[156:159], v[84:87]
    v_mfma_f32_16x16x32_bf16 v[88:91], v[152:155], v[160:163], v[88:91]
    v_mfma_f32_16x16x32_bf16 v[92:95], v[152:155], v[164:167], v[92:95]
    v_mfma_f32_16x16x32_bf16 v[96:99], v[152:155], v[168:171], v[96:99]
    s_barrier
    s_waitcnt lgkmcnt(0)
    v_mfma_f32_16x16x32_bf16 v[20:23], v[100:103], v[120:123], v[20:23]
    ds_read_b128 v[156:159], v4 offset:1024
    v_mfma_f32_16x16x32_bf16 v[24:27], v[100:103], v[124:127], v[24:27]
    ds_read_b128 v[160:163], v4 offset:3072
    v_mfma_f32_16x16x32_bf16 v[28:31], v[100:103], v[128:131], v[28:31]
    ds_read_b128 v[164:167], v4 offset:5120
    v_mfma_f32_16x16x32_bf16 v[32:35], v[100:103], v[132:135], v[32:35]
    ds_read_b128 v[168:171], v4 offset:7168
    v_mfma_f32_16x16x32_bf16 v[36:39], v[104:107], v[120:123], v[36:39]
    ds_read_b64_tr_b16 v[136:137], v5 offset:10240
    v_mfma_f32_16x16x32_bf16 v[40:43], v[104:107], v[124:127], v[40:43]
    ds_read_b64_tr_b16 v[138:139], v5 offset:11520
    v_mfma_f32_16x16x32_bf16 v[44:47], v[104:107], v[128:131], v[44:47]
    ds_read_b64_tr_b16 v[140:141], v5 offset:10272
    v_mfma_f32_16x16x32_bf16 v[48:51], v[104:107], v[132:135], v[48:51]
    ds_read_b64_tr_b16 v[142:143], v5 offset:11552
    v_mfma_f32_16x16x32_bf16 v[52:55], v[108:111], v[120:123], v[52:55]
    ds_read_b64_tr_b16 v[144:145], v5 offset:10304
    v_mfma_f32_16x16x32_bf16 v[56:59], v[108:111], v[124:127], v[56:59]
    ds_read_b64_tr_b16 v[146:147], v5 offset:11584
    v_mfma_f32_16x16x32_bf16 v[60:63], v[108:111], v[128:131], v[60:63]
    ds_read_b64_tr_b16 v[148:149], v5 offset:10336
    v_mfma_f32_16x16x32_bf16 v[64:67], v[108:111], v[132:135], v[64:67]
    ds_read_b64_tr_b16 v[150:151], v5 offset:11616
    v_mfma_f32_16x16x32_bf16 v[68:71], v[112:115], v[120:123], v[68:71]
    ds_read_b64_tr_b16 v[152:153], v6 offset:10368
    v_mfma_f32_16x16x32_bf16 v[72:75], v[112:115], v[124:127], v[72:75]
    ds_read_b64_tr_b16 v[154:155], v6 offset:11648
    v_mfma_f32_16x16x32_bf16 v[76:79], v[112:115], v[128:131], v[76:79]
    v_mfma_f32_16x16x32_bf16 v[80:83], v[112:115], v[132:135], v[80:83]
    v_mfma_f32_16x16x32_bf16 v[84:87], v[116:119], v[120:123], v[84:87]
    v_mfma_f32_16x16x32_bf16 v[88:91], v[116:119], v[124:127], v[88:91]
    v_mfma_f32_16x16x32_bf16 v[92:95], v[116:119], v[128:131], v[92:95]
    v_mfma_f32_16x16x32_bf16 v[96:99], v[116:119], v[132:135], v[96:99]
    s_waitcnt lgkmcnt(0)
    v_mfma_f32_16x16x32_bf16 v[20:23], v[136:139], v[156:159], v[20:23]
    ds_read_b128 v[120:123], v7
    v_mfma_f32_16x16x32_bf16 v[24:27], v[136:139], v[160:163], v[24:27]
    ds_read_b128 v[124:127], v7 offset:2048
    v_mfma_f32_16x16x32_bf16 v[28:31], v[136:139], v[164:167], v[28:31]
    ds_read_b128 v[128:131], v7 offset:4096
    v_mfma_f32_16x16x32_bf16 v[32:35], v[136:139], v[168:171], v[32:35]
    ds_read_b128 v[132:135], v7 offset:6144
    v_mfma_f32_16x16x32_bf16 v[36:39], v[140:143], v[156:159], v[36:39]
    ds_read_b64_tr_b16 v[100:101], v8
    v_mfma_f32_16x16x32_bf16 v[40:43], v[140:143], v[160:163], v[40:43]
    ds_read_b64_tr_b16 v[102:103], v8 offset:1280
    v_mfma_f32_16x16x32_bf16 v[44:47], v[140:143], v[164:167], v[44:47]
    ds_read_b64_tr_b16 v[104:105], v8 offset:32
    v_mfma_f32_16x16x32_bf16 v[48:51], v[140:143], v[168:171], v[48:51]
    ds_read_b64_tr_b16 v[106:107], v8 offset:1312
    v_mfma_f32_16x16x32_bf16 v[52:55], v[144:147], v[156:159], v[52:55]
    ds_read_b64_tr_b16 v[108:109], v8 offset:64
    v_mfma_f32_16x16x32_bf16 v[56:59], v[144:147], v[160:163], v[56:59]
    ds_read_b64_tr_b16 v[110:111], v8 offset:1344
    v_mfma_f32_16x16x32_bf16 v[60:63], v[144:147], v[164:167], v[60:63]
    ds_read_b64_tr_b16 v[112:113], v8 offset:96
    v_mfma_f32_16x16x32_bf16 v[64:67], v[144:147], v[168:171], v[64:67]
    ds_read_b64_tr_b16 v[114:115], v8 offset:1376
    v_mfma_f32_16x16x32_bf16 v[68:71], v[148:151], v[156:159], v[68:71]
    ds_read_b64_tr_b16 v[116:117], v9 offset:128
    v_mfma_f32_16x16x32_bf16 v[72:75], v[148:151], v[160:163], v[72:75]
    ds_read_b64_tr_b16 v[118:119], v9 offset:1408
    v_mfma_f32_16x16x32_bf16 v[76:79], v[148:151], v[164:167], v[76:79]
    v_mfma_f32_16x16x32_bf16 v[80:83], v[148:151], v[168:171], v[80:83]
    v_mfma_f32_16x16x32_bf16 v[84:87], v[152:155], v[156:159], v[84:87]
    v_mfma_f32_16x16x32_bf16 v[88:91], v[152:155], v[160:163], v[88:91]
    v_mfma_f32_16x16x32_bf16 v[92:95], v[152:155], v[164:167], v[92:95]
    v_mfma_f32_16x16x32_bf16 v[96:99], v[152:155], v[168:171], v[96:99]
    s_barrier
    s_waitcnt lgkmcnt(0)
    v_mfma_f32_16x16x32_bf16 v[20:23], v[100:103], v[120:123], v[20:23]
    ds_read_b128 v[156:159], v7 offset:1024
    v_mfma_f32_16x16x32_bf16 v[24:27], v[100:103], v[124:127], v[24:27]
    ds_read_b128 v[160:163], v7 offset:3072
    v_mfma_f32_16x16x32_bf16 v[28:31], v[100:103], v[128:131], v[28:31]
    ds_read_b128 v[164:167], v7 offset:5120
    v_mfma_f32_16x16x32_bf16 v[32:35], v[100:103], v[132:135], v[32:35]
    ds_read_b128 v[168:171], v7 offset:7168
    v_mfma_f32_16x16x32_bf16 v[36:39], v[104:107], v[120:123], v[36:39]
    ds_read_b64_tr_b16 v[136:137], v8 offset:10240
    v_mfma_f32_16x16x32_bf16 v[40:43], v[104:107], v[124:127], v[40:43]
    ds_read_b64_tr_b16 v[138:139], v8 offset:11520
    v_mfma_f32_16x16x32_bf16 v[44:47], v[104:107], v[128:131], v[44:47]
    ds_read_b64_tr_b16 v[140:141], v8 offset:10272
    v_mfma_f32_16x16x32_bf16 v[48:51], v[104:107], v[132:135], v[48:51]
    ds_read_b64_tr_b16 v[142:143], v8 offset:11552
    v_mfma_f32_16x16x32_bf16 v[52:55], v[108:111], v[120:123], v[52:55]
    ds_read_b64_tr_b16 v[144:145], v8 offset:10304
    v_mfma_f32_16x16x32_bf16 v[56:59], v[108:111], v[124:127], v[56:59]
    ds_read_b64_tr_b16 v[146:147], v8 offset:11584
    v_mfma_f32_16x16x32_bf16 v[60:63], v[108:111], v[128:131], v[60:63]
    ds_read_b64_tr_b16 v[148:149], v8 offset:10336
    v_mfma_f32_16x16x32_bf16 v[64:67], v[108:111], v[132:135], v[64:67]
    ds_read_b64_tr_b16 v[150:151], v8 offset:11616
    v_mfma_f32_16x16x32_bf16 v[68:71], v[112:115], v[120:123], v[68:71]
    ds_read_b64_tr_b16 v[152:153], v9 offset:10368
    v_mfma_f32_16x16x32_bf16 v[72:75], v[112:115], v[124:127], v[72:75]
    ds_read_b64_tr_b16 v[154:155], v9 offset:11648
    v_mfma_f32_16x16x32_bf16 v[76:79], v[112:115], v[128:131], v[76:79]
    v_mfma_f32_16x16x32_bf16 v[80:83], v[112:115], v[132:135], v[80:83]
    v_mfma_f32_16x16x32_bf16 v[84:87], v[116:119], v[120:123], v[84:87]
    v_mfma_f32_16x16x32_bf16 v[88:91], v[116:119], v[124:127], v[88:91]
    v_mfma_f32_16x16x32_bf16 v[92:95], v[116:119], v[128:131], v[92:95]
    v_mfma_f32_16x16x32_bf16 v[96:99], v[116:119], v[132:135], v[96:99]
    s_waitcnt lgkmcnt(0)
    v_mfma_f32_16x16x32_bf16 v[20:23], v[136:139], v[156:159], v[20:23]
    ds_read_b128 v[120:123], v10
    v_mfma_f32_16x16x32_bf16 v[24:27], v[136:139], v[160:163], v[24:27]
    ds_read_b128 v[124:127], v10 offset:2048
    v_mfma_f32_16x16x32_bf16 v[28:31], v[136:139], v[164:167], v[28:31]
    ds_read_b128 v[128:131], v10 offset:4096
    v_mfma_f32_16x16x32_bf16 v[32:35], v[136:139], v[168:171], v[32:35]
    ds_read_b128 v[132:135], v10 offset:6144
    v_mfma_f32_16x16x32_bf16 v[36:39], v[140:143], v[156:159], v[36:39]
    ds_read_b64_tr_b16 v[100:101], v11
    v_mfma_f32_16x16x32_bf16 v[40:43], v[140:143], v[160:163], v[40:43]
    ds_read_b64_tr_b16 v[102:103], v11 offset:1280
    v_mfma_f32_16x16x32_bf16 v[44:47], v[140:143], v[164:167], v[44:47]
    ds_read_b64_tr_b16 v[104:105], v11 offset:32
    v_mfma_f32_16x16x32_bf16 v[48:51], v[140:143], v[168:171], v[48:51]
    ds_read_b64_tr_b16 v[106:107], v11 offset:1312
    v_mfma_f32_16x16x32_bf16 v[52:55], v[144:147], v[156:159], v[52:55]
    ds_read_b64_tr_b16 v[108:109], v11 offset:64
    v_mfma_f32_16x16x32_bf16 v[56:59], v[144:147], v[160:163], v[56:59]
    ds_read_b64_tr_b16 v[110:111], v11 offset:1344
    v_mfma_f32_16x16x32_bf16 v[60:63], v[144:147], v[164:167], v[60:63]
    ds_read_b64_tr_b16 v[112:113], v11 offset:96
    v_mfma_f32_16x16x32_bf16 v[64:67], v[144:147], v[168:171], v[64:67]
    ds_read_b64_tr_b16 v[114:115], v11 offset:1376
    v_mfma_f32_16x16x32_bf16 v[68:71], v[148:151], v[156:159], v[68:71]
    ds_read_b64_tr_b16 v[116:117], v12 offset:128
    v_mfma_f32_16x16x32_bf16 v[72:75], v[148:151], v[160:163], v[72:75]
    ds_read_b64_tr_b16 v[118:119], v12 offset:1408
    v_mfma_f32_16x16x32_bf16 v[76:79], v[148:151], v[164:167], v[76:79]
    v_mfma_f32_16x16x32_bf16 v[80:83], v[148:151], v[168:171], v[80:83]
    v_mfma_f32_16x16x32_bf16 v[84:87], v[152:155], v[156:159], v[84:87]
    v_mfma_f32_16x16x32_bf16 v[88:91], v[152:155], v[160:163], v[88:91]
    v_mfma_f32_16x16x32_bf16 v[92:95], v[152:155], v[164:167], v[92:95]
    v_mfma_f32_16x16x32_bf16 v[96:99], v[152:155], v[168:171], v[96:99]
    s_barrier
    s_waitcnt lgkmcnt(0)
    v_mfma_f32_16x16x32_bf16 v[20:23], v[100:103], v[120:123], v[20:23]
    ds_read_b128 v[156:159], v10 offset:1024
    v_mfma_f32_16x16x32_bf16 v[24:27], v[100:103], v[124:127], v[24:27]
    ds_read_b128 v[160:163], v10 offset:3072
    v_mfma_f32_16x16x32_bf16 v[28:31], v[100:103], v[128:131], v[28:31]
    ds_read_b128 v[164:167], v10 offset:5120
    v_mfma_f32_16x16x32_bf16 v[32:35], v[100:103], v[132:135], v[32:35]
    ds_read_b128 v[168:171], v10 offset:7168
    v_mfma_f32_16x16x32_bf16 v[36:39], v[104:107], v[120:123], v[36:39]
    ds_read_b64_tr_b16 v[136:137], v11 offset:10240
    v_mfma_f32_16x16x32_bf16 v[40:43], v[104:107], v[124:127], v[40:43]
    ds_read_b64_tr_b16 v[138:139], v11 offset:11520
    v_mfma_f32_16x16x32_bf16 v[44:47], v[104:107], v[128:131], v[44:47]
    ds_read_b64_tr_b16 v[140:141], v11 offset:10272
    v_mfma_f32_16x16x32_bf16 v[48:51], v[104:107], v[132:135], v[48:51]
    ds_read_b64_tr_b16 v[142:143], v11 offset:11552
    v_mfma_f32_16x16x32_bf16 v[52:55], v[108:111], v[120:123], v[52:55]
    ds_read_b64_tr_b16 v[144:145], v11 offset:10304
    v_mfma_f32_16x16x32_bf16 v[56:59], v[108:111], v[124:127], v[56:59]
    ds_read_b64_tr_b16 v[146:147], v11 offset:11584
    v_mfma_f32_16x16x32_bf16 v[60:63], v[108:111], v[128:131], v[60:63]
    ds_read_b64_tr_b16 v[148:149], v11 offset:10336
    v_mfma_f32_16x16x32_bf16 v[64:67], v[108:111], v[132:135], v[64:67]
    ds_read_b64_tr_b16 v[150:151], v11 offset:11616
    v_mfma_f32_16x16x32_bf16 v[68:71], v[112:115], v[120:123], v[68:71]
    ds_read_b64_tr_b16 v[152:153], v12 offset:10368
    v_mfma_f32_16x16x32_bf16 v[72:75], v[112:115], v[124:127], v[72:75]
    ds_read_b64_tr_b16 v[154:155], v12 offset:11648
    v_mfma_f32_16x16x32_bf16 v[76:79], v[112:115], v[128:131], v[76:79]
    v_mfma_f32_16x16x32_bf16 v[80:83], v[112:115], v[132:135], v[80:83]
    v_mfma_f32_16x16x32_bf16 v[84:87], v[116:119], v[120:123], v[84:87]
    v_mfma_f32_16x16x32_bf16 v[88:91], v[116:119], v[124:127], v[88:91]
    v_mfma_f32_16x16x32_bf16 v[92:95], v[116:119], v[128:131], v[92:95]
    v_mfma_f32_16x16x32_bf16 v[96:99], v[116:119], v[132:135], v[96:99]
    s_waitcnt lgkmcnt(0)
    v_mfma_f32_16x16x32_bf16 v[20:23], v[136:139], v[156:159], v[20:23]
    ds_read_b128 v[120:123], v13
    v_mfma_f32_16x16x32_bf16 v[24:27], v[136:139], v[160:163], v[24:27]
    ds_read_b128 v[124:127], v13 offset:2048
    v_mfma_f32_16x16x32_bf16 v[28:31], v[136:139], v[164:167], v[28:31]
    ds_read_b128 v[128:131], v13 offset:4096
    v_mfma_f32_16x16x32_bf16 v[32:35], v[136:139], v[168:171], v[32:35]
    ds_read_b128 v[132:135], v13 offset:6144
    v_mfma_f32_16x16x32_bf16 v[36:39], v[140:143], v[156:159], v[36:39]
    ds_read_b64_tr_b16 v[100:101], v14
    v_mfma_f32_16x16x32_bf16 v[40:43], v[140:143], v[160:163], v[40:43]
    ds_read_b64_tr_b16 v[102:103], v14 offset:1280
    v_mfma_f32_16x16x32_bf16 v[44:47], v[140:143], v[164:167], v[44:47]
    ds_read_b64_tr_b16 v[104:105], v14 offset:32
    v_mfma_f32_16x16x32_bf16 v[48:51], v[140:143], v[168:171], v[48:51]
    ds_read_b64_tr_b16 v[106:107], v14 offset:1312
    v_mfma_f32_16x16x32_bf16 v[52:55], v[144:147], v[156:159], v[52:55]
    ds_read_b64_tr_b16 v[108:109], v14 offset:64
    v_mfma_f32_16x16x32_bf16 v[56:59], v[144:147], v[160:163], v[56:59]
    ds_read_b64_tr_b16 v[110:111], v14 offset:1344
    v_mfma_f32_16x16x32_bf16 v[60:63], v[144:147], v[164:167], v[60:63]
    ds_read_b64_tr_b16 v[112:113], v14 offset:96
    v_mfma_f32_16x16x32_bf16 v[64:67], v[144:147], v[168:171], v[64:67]
    ds_read_b64_tr_b16 v[114:115], v14 offset:1376
    v_mfma_f32_16x16x32_bf16 v[68:71], v[148:151], v[156:159], v[68:71]
    ds_read_b64_tr_b16 v[116:117], v15 offset:128
    v_mfma_f32_16x16x32_bf16 v[72:75], v[148:151], v[160:163], v[72:75]
    ds_read_b64_tr_b16 v[118:119], v15 offset:1408
    v_mfma_f32_16x16x32_bf16 v[76:79], v[148:151], v[164:167], v[76:79]
    v_mfma_f32_16x16x32_bf16 v[80:83], v[148:151], v[168:171], v[80:83]
    v_mfma_f32_16x16x32_bf16 v[84:87], v[152:155], v[156:159], v[84:87]
    v_mfma_f32_16x16x32_bf16 v[88:91], v[152:155], v[160:163], v[88:91]
    v_mfma_f32_16x16x32_bf16 v[92:95], v[152:155], v[164:167], v[92:95]
    v_mfma_f32_16x16x32_bf16 v[96:99], v[152:155], v[168:171], v[96:99]
    s_barrier
    s_waitcnt lgkmcnt(0)
    v_mfma_f32_16x16x32_bf16 v[20:23], v[100:103], v[120:123], v[20:23]
    ds_read_b128 v[156:159], v13 offset:1024
    v_mfma_f32_16x16x32_bf16 v[24:27], v[100:103], v[124:127], v[24:27]
    ds_read_b128 v[160:163], v13 offset:3072
    v_mfma_f32_16x16x32_bf16 v[28:31], v[100:103], v[128:131], v[28:31]
    ds_read_b128 v[164:167], v13 offset:5120
    v_mfma_f32_16x16x32_bf16 v[32:35], v[100:103], v[132:135], v[32:35]
    ds_read_b128 v[168:171], v13 offset:7168
    v_mfma_f32_16x16x32_bf16 v[36:39], v[104:107], v[120:123], v[36:39]
    ds_read_b64_tr_b16 v[136:137], v14 offset:10240
    v_mfma_f32_16x16x32_bf16 v[40:43], v[104:107], v[124:127], v[40:43]
    ds_read_b64_tr_b16 v[138:139], v14 offset:11520
    v_mfma_f32_16x16x32_bf16 v[44:47], v[104:107], v[128:131], v[44:47]
    ds_read_b64_tr_b16 v[140:141], v14 offset:10272
    v_mfma_f32_16x16x32_bf16 v[48:51], v[104:107], v[132:135], v[48:51]
    ds_read_b64_tr_b16 v[142:143], v14 offset:11552
    v_mfma_f32_16x16x32_bf16 v[52:55], v[108:111], v[120:123], v[52:55]
    ds_read_b64_tr_b16 v[144:145], v14 offset:10304
    v_mfma_f32_16x16x32_bf16 v[56:59], v[108:111], v[124:127], v[56:59]
    ds_read_b64_tr_b16 v[146:147], v14 offset:11584
    v_mfma_f32_16x16x32_bf16 v[60:63], v[108:111], v[128:131], v[60:63]
    ds_read_b64_tr_b16 v[148:149], v14 offset:10336
    v_mfma_f32_16x16x32_bf16 v[64:67], v[108:111], v[132:135], v[64:67]
    ds_read_b64_tr_b16 v[150:151], v14 offset:11616
    v_mfma_f32_16x16x32_bf16 v[68:71], v[112:115], v[120:123], v[68:71]
    ds_read_b64_tr_b16 v[152:153], v15 offset:10368
    v_mfma_f32_16x16x32_bf16 v[72:75], v[112:115], v[124:127], v[72:75]
    ds_read_b64_tr_b16 v[154:155], v15 offset:11648
    v_mfma_f32_16x16x32_bf16 v[76:79], v[112:115], v[128:131], v[76:79]
    v_mfma_f32_16x16x32_bf16 v[80:83], v[112:115], v[132:135], v[80:83]
    v_mfma_f32_16x16x32_bf16 v[84:87], v[116:119], v[120:123], v[84:87]
    v_mfma_f32_16x16x32_bf16 v[88:91], v[116:119], v[124:127], v[88:91]
    v_mfma_f32_16x16x32_bf16 v[92:95], v[116:119], v[128:131], v[92:95]
    v_mfma_f32_16x16x32_bf16 v[96:99], v[116:119], v[132:135], v[96:99]
    s_waitcnt lgkmcnt(0)
    v_mfma_f32_16x16x32_bf16 v[20:23], v[136:139], v[156:159], v[20:23]
    v_mfma_f32_16x16x32_bf16 v[24:27], v[136:139], v[160:163], v[24:27]
    v_mfma_f32_16x16x32_bf16 v[28:31], v[136:139], v[164:167], v[28:31]
    v_mfma_f32_16x16x32_bf16 v[32:35], v[136:139], v[168:171], v[32:35]
    v_mfma_f32_16x16x32_bf16 v[36:39], v[140:143], v[156:159], v[36:39]
    v_mfma_f32_16x16x32_bf16 v[40:43], v[140:143], v[160:163], v[40:43]
    v_mfma_f32_16x16x32_bf16 v[44:47], v[140:143], v[164:167], v[44:47]
    v_mfma_f32_16x16x32_bf16 v[48:51], v[140:143], v[168:171], v[48:51]
    v_mfma_f32_16x16x32_bf16 v[52:55], v[144:147], v[156:159], v[52:55]
    v_mfma_f32_16x16x32_bf16 v[56:59], v[144:147], v[160:163], v[56:59]
    v_mfma_f32_16x16x32_bf16 v[60:63], v[144:147], v[164:167], v[60:63]
    v_mfma_f32_16x16x32_bf16 v[64:67], v[144:147], v[168:171], v[64:67]
    v_mfma_f32_16x16x32_bf16 v[68:71], v[148:151], v[156:159], v[68:71]
    v_mfma_f32_16x16x32_bf16 v[72:75], v[148:151], v[160:163], v[72:75]
    v_mfma_f32_16x16x32_bf16 v[76:79], v[148:151], v[164:167], v[76:79]
    v_mfma_f32_16x16x32_bf16 v[80:83], v[148:151], v[168:171], v[80:83]
    v_mfma_f32_16x16x32_bf16 v[84:87], v[152:155], v[156:159], v[84:87]
    v_mfma_f32_16x16x32_bf16 v[88:91], v[152:155], v[160:163], v[88:91]
    v_mfma_f32_16x16x32_bf16 v[92:95], v[152:155], v[164:167], v[92:95]
    v_mfma_f32_16x16x32_bf16 v[96:99], v[152:155], v[168:171], v[96:99]
    s_lshl_b32 s8, s33, 2
    s_add_u32 s8, s8, s5
    s_lshl_b32 s8, s8, 2
    s_add_u32 s8, s8, s3
    s_mul_i32 s9, s8, 10240
    s_add_u32 s9, s9, 16777216
    v_cvt_pk_bf16_f32 v100, v20, v21
    v_cvt_pk_bf16_f32 v101, v22, v23
    v_cvt_pk_bf16_f32 v102, v24, v25
    v_cvt_pk_bf16_f32 v103, v26, v27
    buffer_store_dwordx4 v[100:103], v2, s[12:15], s9 offen
    v_cvt_pk_bf16_f32 v104, v28, v29
    v_cvt_pk_bf16_f32 v105, v30, v31
    v_cvt_pk_bf16_f32 v106, v32, v33
    v_cvt_pk_bf16_f32 v107, v34, v35
    buffer_store_dwordx4 v[104:107], v2, s[12:15], s9 offen offset:1024
    v_cvt_pk_bf16_f32 v108, v36, v37
    v_cvt_pk_bf16_f32 v109, v38, v39
    v_cvt_pk_bf16_f32 v110, v40, v41
    v_cvt_pk_bf16_f32 v111, v42, v43
    buffer_store_dwordx4 v[108:111], v2, s[12:15], s9 offen offset:2048
    v_cvt_pk_bf16_f32 v112, v44, v45
    v_cvt_pk_bf16_f32 v113, v46, v47
    v_cvt_pk_bf16_f32 v114, v48, v49
    v_cvt_pk_bf16_f32 v115, v50, v51
    buffer_store_dwordx4 v[112:115], v2, s[12:15], s9 offen offset:3072
    s_add_u32 s9, s9, 4096
    v_cvt_pk_bf16_f32 v116, v52, v53
    v_cvt_pk_bf16_f32 v117, v54, v55
    v_cvt_pk_bf16_f32 v118, v56, v57
    v_cvt_pk_bf16_f32 v119, v58, v59
    buffer_store_dwordx4 v[116:119], v2, s[12:15], s9 offen
    v_cvt_pk_bf16_f32 v120, v60, v61
    v_cvt_pk_bf16_f32 v121, v62, v63
    v_cvt_pk_bf16_f32 v122, v64, v65
    v_cvt_pk_bf16_f32 v123, v66, v67
    buffer_store_dwordx4 v[120:123], v2, s[12:15], s9 offen offset:1024
    v_cvt_pk_bf16_f32 v124, v68, v69
    v_cvt_pk_bf16_f32 v125, v70, v71
    v_cvt_pk_bf16_f32 v126, v72, v73
    v_cvt_pk_bf16_f32 v127, v74, v75
    buffer_store_dwordx4 v[124:127], v2, s[12:15], s9 offen offset:2048
    v_cvt_pk_bf16_f32 v128, v76, v77
    v_cvt_pk_bf16_f32 v129, v78, v79
    v_cvt_pk_bf16_f32 v130, v80, v81
    v_cvt_pk_bf16_f32 v131, v82, v83
    buffer_store_dwordx4 v[128:131], v2, s[12:15], s9 offen offset:3072
    s_add_u32 s9, s9, 4096
    v_cvt_pk_bf16_f32 v132, v84, v85
    v_cvt_pk_bf16_f32 v133, v86, v87
    v_cvt_pk_bf16_f32 v134, v88, v89
    v_cvt_pk_bf16_f32 v135, v90, v91
    buffer_store_dwordx4 v[132:135], v2, s[12:15], s9 offen
    v_cvt_pk_bf16_f32 v136, v92, v93
    v_cvt_pk_bf16_f32 v137, v94, v95
    v_cvt_pk_bf16_f32 v138, v96, v97
    v_cvt_pk_bf16_f32 v139, v98, v99
    buffer_store_dwordx4 v[136:139], v2, s[12:15], s9 offen offset:1024
    s_waitcnt vmcnt(0)
L_op_done:
L_attn_end:
    s_endpgm

    .globl reduce_kernel
    .p2align 8
    .type reduce_kernel,@function
reduce_kernel:
    s_cmp_ge_u32 s2, 256
    s_cbranch_scc1 L_rd_end
    s_load_dwordx2 s[20:21], s[0:1], 96
    s_load_dwordx2 s[22:23], s[0:1], 80
    v_lshrrev_b32 v6, 6, v0
    v_and_b32 v1, 63, v0
    v_readfirstlane_b32 s3, v6
    v_lshlrev_b32 v2, 4, v1
    s_nop 0
    s_lshr_b32 s4, s3, 1
    s_and_b32 s5, s3, 1
    s_lshr_b32 s9, s2, 2
    s_and_b32 s10, s2, 3
    s_lshl_b32 s6, s9, 4
    s_add_u32 s6, s6, s10
    s_mul_i32 s6, s6, 10240
    s_lshl_b32 s7, s3, 10
    s_add_u32 s6, s6, s7
    s_add_u32 s6, s6, 16777216
    s_waitcnt lgkmcnt(0)
    s_mov_b32 s12, s20
    s_mov_b32 s13, s21
    s_mov_b32 s14, 67108864
    s_mov_b32 s15, 0x00020000
    s_mov_b32 s16, s22
    s_mov_b32 s17, s23
    s_mov_b32 s18, 2621440
    s_mov_b32 s19, 0x00020000
    buffer_load_dwordx4 v[48:51], v2, s[12:15], s6 offen
    s_add_u32 s6, s6, 40960
    buffer_load_dwordx4 v[52:55], v2, s[12:15], s6 offen
    s_add_u32 s6, s6, 40960
    buffer_load_dwordx4 v[56:59], v2, s[12:15], s6 offen
    s_add_u32 s6, s6, 40960
    buffer_load_dwordx4 v[60:63], v2, s[12:15], s6 offen
    s_lshr_b32 s6, s9, 2
    s_and_b32 s6, s6, 7
    s_lshl_b32 s6, s6, 7
    s_and_b32 s7, s10, 1
    s_lshl_b32 s7, s7, 6
    s_add_u32 s6, s6, s7
    s_lshl_b32 s7, s5, 5
    s_add_u32 s6, s6, s7
    v_and_b32 v3, 15, v1
    v_add_u32 v3, s6, v3
    v_mul_u32_u24 v3, 2560, v3
    v_lshrrev_b32 v4, 4, v1
    v_lshl_add_u32 v3, v4, 3, v3
    v_add_u32 v4, 40960, v3
    s_lshr_b32 s6, s9, 5
    s_mul_i32 s6, s6, 1280
    s_and_b32 s7, s9, 3
    s_mul_i32 s7, s7, 320
    s_add_u32 s6, s6, s7
    s_lshr_b32 s7, s10, 1
    s_mul_i32 s7, s7, 160
    s_add_u32 s6, s6, s7
    s_lshl_b32 s7, s4, 5
    s_add_u32 s6, s6, s7
    s_waitcnt vmcnt(0)
    v_lshlrev_b32 v8, 16, v48
    v_and_b32 v9, 0xffff0000, v48
    v_lshlrev_b32 v10, 16, v49
    v_and_b32 v11, 0xffff0000, v49
    v_lshlrev_b32 v12, 16, v50
    v_and_b32 v13, 0xffff0000, v50
    v_lshlrev_b32 v14, 16, v51
    v_and_b32 v15, 0xffff0000, v51
    v_lshlrev_b32 v16, 16, v52
    v_and_b32 v17, 0xffff0000, v52
    v_lshlrev_b32 v18, 16, v53
    v_and_b32 v19, 0xffff0000, v53
    v_lshlrev_b32 v20, 16, v54
    v_and_b32 v21, 0xffff0000, v54
    v_lshlrev_b32 v22, 16, v55
    v_and_b32 v23, 0xffff0000, v55
    v_lshlrev_b32 v24, 16, v56
    v_and_b32 v25, 0xffff0000, v56
    v_lshlrev_b32 v26, 16, v57
    v_and_b32 v27, 0xffff0000, v57
    v_lshlrev_b32 v28, 16, v58
    v_and_b32 v29, 0xffff0000, v58
    v_lshlrev_b32 v30, 16, v59
    v_and_b32 v31, 0xffff0000, v59
    v_lshlrev_b32 v32, 16, v60
    v_and_b32 v33, 0xffff0000, v60
    v_lshlrev_b32 v34, 16, v61
    v_and_b32 v35, 0xffff0000, v61
    v_lshlrev_b32 v36, 16, v62
    v_and_b32 v37, 0xffff0000, v62
    v_lshlrev_b32 v38, 16, v63
    v_and_b32 v39, 0xffff0000, v63
    v_add_f32 v8, v8, v16
    v_add_f32 v24, v24, v32
    v_add_f32 v9, v9, v17
    v_add_f32 v25, v25, v33
    v_add_f32 v10, v10, v18
    v_add_f32 v26, v26, v34
    v_add_f32 v11, v11, v19
    v_add_f32 v27, v27, v35
    v_add_f32 v12, v12, v20
    v_add_f32 v28, v28, v36
    v_add_f32 v13, v13, v21
    v_add_f32 v29, v29, v37
    v_add_f32 v14, v14, v22
    v_add_f32 v30, v30, v38
    v_add_f32 v15, v15, v23
    v_add_f32 v31, v31, v39
    v_add_f32 v8, v8, v24
    v_add_f32 v9, v9, v25
    v_add_f32 v10, v10, v26
    v_add_f32 v11, v11, v27
    v_add_f32 v12, v12, v28
    v_add_f32 v13, v13, v29
    v_add_f32 v14, v14, v30
    v_add_f32 v15, v15, v31
    v_cvt_pk_bf16_f32 v40, v8, v9
    v_cvt_pk_bf16_f32 v41, v10, v11
    buffer_store_dwordx2 v[40:41], v3, s[16:19], s6 offen
    v_cvt_pk_bf16_f32 v42, v12, v13
    v_cvt_pk_bf16_f32 v43, v14, v15
    buffer_store_dwordx2 v[42:43], v4, s[16:19], s6 offen
    s_waitcnt vmcnt(0)
L_rd_end:
    s_endpgm
.section .rodata,"a"
.p2align 6
.amdhsa_kernel attn_kernel
  .amdhsa_next_free_vgpr 256
  .amdhsa_next_free_sgpr 102
  .amdhsa_accum_offset 256
  .amdhsa_group_segment_fixed_size 0
  .amdhsa_kernarg_size 104
  .amdhsa_user_sgpr_count 2
  .amdhsa_user_sgpr_kernarg_segment_ptr 1
  .amdhsa_system_sgpr_workgroup_id_x 1
  .amdhsa_float_denorm_mode_32 3
  .amdhsa_float_denorm_mode_16_64 3
.end_amdhsa_kernel
.p2align 6
.amdhsa_kernel reduce_kernel
  .amdhsa_next_free_vgpr 64
  .amdhsa_next_free_sgpr 102
  .amdhsa_accum_offset 64
  .amdhsa_group_segment_fixed_size 0
  .amdhsa_kernarg_size 104
  .amdhsa_user_sgpr_count 2
  .amdhsa_user_sgpr_kernarg_segment_ptr 1
  .amdhsa_system_sgpr_workgroup_id_x 1
  .amdhsa_float_denorm_mode_32 3
  .amdhsa_float_denorm_mode_16_64 3
.end_amdhsa_kernel
```
